```python
import torch

def _softmax(x, axis=-1):
    return torch.softmax(x, dim=axis)
def _gelu(x):
    return torch.nn.functional.gelu(x, approximate="tanh")
def _silu(x):
    return torch.nn.functional.silu(x)
def _sigmoid(x):
    return torch.sigmoid(x)
def _layernorm(x, axis=-1, eps=1e-5):
    m = x.mean(dim=axis, keepdim=True)
    v = x.var(dim=axis, keepdim=True, unbiased=False)
    return (x - m) / torch.sqrt(v + eps)
def _scatter_add(tgt, idx, src, axis=0):
    return tgt.clone().index_add_(axis, idx, src)
def _segment_sum(src, seg, n):
    out = torch.zeros((n,) + src.shape[1:], dtype=src.dtype)
    return out.index_add_(0, seg, src)
def _pad(x, pw):
    flat = tuple(v for pair in reversed(pw) for v in pair)
    return torch.nn.functional.pad(x, flat)

kernel_name = 'parallel_sum__ssm_conv_s4__swiglu_ffn__prompt'

def setup_inputs():

    _w = (lambda a: (lambda t: t.to(torch.bfloat16) if t.is_floating_point() else t)(torch.as_tensor(a)))
    def _A_setup():
        B, L, D, N = 1, 2048, 512, 128
        A_re = -(lambda _x: torch.exp(torch.as_tensor(_x)))((lambda *s: torch.randn(*s, dtype=torch.bfloat16) * 3.2)(D, N))
        A_im = torch.pi * (lambda *s: torch.randn(*s, dtype=torch.bfloat16) * 0.1)(D, N)
        B_re = (lambda *s: torch.randn(*s, dtype=torch.bfloat16) * 0.4)(D, N)
        B_im = (lambda *s: torch.randn(*s, dtype=torch.bfloat16) * 0.4)(D, N)
        C_re = (lambda *s: torch.randn(*s, dtype=torch.bfloat16) * 0.4)(D, N)
        C_im = (lambda *s: torch.randn(*s, dtype=torch.bfloat16) * 0.4)(D, N)
        log_dt = (lambda *s: torch.randn(*s, dtype=torch.bfloat16) * 0.1)(D) * 0.5 - 4.0
        Dskip = (lambda *s: torch.randn(*s, dtype=torch.bfloat16) * 0.2)(D)
        return {
            "u": _w((lambda *s: torch.randn(*s, dtype=torch.bfloat16) * 0.05)(B, L, D)),
            "A_re": _w(A_re),
            "A_im": _w(A_im),
            "B_re": _w(B_re),
            "B_im": _w(B_im),
            "C_re": _w(C_re),
            "C_im": _w(C_im),
            "log_dt": _w(log_dt),
            "Dskip": _w(Dskip),
        }
    _A_in = _A_setup()

    def _B_setup():
        B, S, D, F = 1, 2048, 512, 1376
        return {
            "x": _w((lambda *s: torch.randn(*s, dtype=torch.bfloat16) * 0.05)(B, S, D)),
            "w_gate": _w((lambda *s: torch.randn(*s, dtype=torch.bfloat16) * 0.05)(D, F)),
            "w_up": _w((lambda *s: torch.randn(*s, dtype=torch.bfloat16) * 0.05)(D, F)),
            "w_down": _w((lambda *s: torch.randn(*s, dtype=torch.bfloat16) * 0.05)(F, D)),
        }
    _B_in = _B_setup()

    return {
        "A_u": _A_in["u"],
        "A_A_re": _A_in["A_re"],
        "A_A_im": _A_in["A_im"],
        "A_B_re": _A_in["B_re"],
        "A_B_im": _A_in["B_im"],
        "A_C_re": _A_in["C_re"],
        "A_C_im": _A_in["C_im"],
        "A_log_dt": _A_in["log_dt"],
        "A_Dskip": _A_in["Dskip"],
        "B_x": _B_in["x"],
        "B_w_gate": _B_in["w_gate"],
        "B_w_up": _B_in["w_up"],
        "B_w_down": _B_in["w_down"],
    }

def reference(A_u, A_A_re, A_A_im, A_B_re, A_B_im, A_C_re, A_C_im, A_log_dt, A_Dskip, B_x, B_w_gate, B_w_up, B_w_down):
    def _A_ref(u, A_re, A_im, B_re, B_im, C_re, C_im, log_dt, Dskip):
        Bsz, L, D = u.shape
        dt = torch.exp(log_dt)[:, None]
        A = A_re + 1j * A_im
        Bc = B_re + 1j * B_im
        Cc = C_re + 1j * C_im
        logdA = dt * A
        dB = dt * Bc
        l = (lambda x, dt: x.to(dt))(torch.arange(L), A_re.dtype)
        P = torch.exp(logdA[:, :, None] * l[None, None, :])
        K = torch.einsum("dn,dnl,dn->dl", Cc, P, dB).real
        L2 = 2 * L
        Kp = _pad(K, ((0, 0), (0, L)))
        up = (lambda x, *d: x.permute(*d))(u, 0, 2, 1)
        up = _pad(up, ((0, 0), (0, 0), (0, L)))
        Kf = (lambda x, axes=(-2,-1): torch.fft.rfft2(x.float(), dim=axes))(Kp[:, None, :], axes=(-2, -1))
        Uf = (lambda x, axes=(-2,-1): torch.fft.rfft2(x.float(), dim=axes))(up[:, :, None, :], axes=(-2, -1))
        Yf = Uf * Kf[None, :, :, :]
        y = (lambda x, s, axes=(-2,-1): torch.fft.irfft2(x, s=s, dim=axes).to(torch.bfloat16))(Yf, (1, L2), axes=(-2, -1))[:, :, 0, :L]
        y = (lambda x, *d: x.permute(*d))(y, 0, 2, 1) + u * Dskip[None, None, :]
        return y

    def _B_ref(x, w_gate, w_up, w_down):
        g = _silu(x @ w_gate)
        u = x @ w_up
        return (g * u) @ w_down

    x = A_u
    xn = _layernorm(x, axis=-1)
    return x + _A_ref(xn, A_A_re, A_A_im, A_B_re, A_B_im, A_C_re, A_C_im, A_log_dt, A_Dskip) + _B_ref(xn, B_w_gate, B_w_up, B_w_down)
```

```asm
; @launch grid=(256,1,1) block=(512,1,1) lds=163840
.amdgcn_target "amdgcn-amd-amdhsa--gfx950"
.text
.globl parallel_sum__ssm_conv_s4__swiglu_ffn__prompt_kernel
.p2align 8
.type parallel_sum__ssm_conv_s4__swiglu_ffn__prompt_kernel,@function
parallel_sum__ssm_conv_s4__swiglu_ffn__prompt_kernel:
    s_cmp_ge_u32 s2, 256
    s_cbranch_scc1 K_END
    s_load_dwordx16 s[16:31], s[0:1], 0
    s_load_dwordx16 s[32:47], s[0:1], 64
    v_lshrrev_b32 v1, 6, v0
    v_and_b32 v0, 63, v0
    v_readfirstlane_b32 s53, v1
    s_and_b32 s54, s2, 7
    s_lshr_b32 s55, s2, 3
    s_and_b32 s48, s54, 1
    s_lshl_b32 s48, s48, 3
    s_and_b32 s68, s55, 7
    s_add_u32 s48, s48, s68
    s_lshr_b32 s49, s54, 1
    s_lshl_b32 s49, s49, 2
    s_lshr_b32 s69, s55, 3
    s_add_u32 s49, s49, s69
    s_mul_i32 s50, s49, 6
    s_min_u32 s50, s50, 80
    s_lshl_b32 s51, s48, 1
    s_lshr_b32 s68, s49, 3
    s_add_u32 s51, s51, s68
    s_and_b32 s52, s49, 7
    v_lshlrev_b32 v2, 4, v0
    s_and_b32 s3, s53, 3
    s_cmp_ge_u32 s53, 4
    s_cbranch_scc1 K_MM
    s_lshr_b32 s55, s3, 1
    s_and_b32 s54, s3, 1
    s_lshl_b32 s70, s52, 6
    s_lshl_b32 s68, s51, 1
    s_add_u32 s70, s70, s68
    s_lshl_b32 s68, s70, 8
    s_lshl_b32 s69, s54, 7
    s_add_u32 s68, s68, s69
    v_lshlrev_b32 v4, 1, v0
    v_add_u32 v4, s68, v4
    s_lshl_b32 s69, s70, 1
    v_mov_b32 v3, s69
    v_mov_b32 v13, 158304
    v_mov_b32 v14, 0
    v_mov_b32 v15, 0
    ds_write_b64 v13, v[14:15]
    ds_write_b64 v13, v[14:15] offset:8
    ds_write_b64 v13, v[14:15] offset:16
    ds_write_b64 v13, v[14:15] offset:24
    s_waitcnt lgkmcnt(0)
    global_load_ushort v38, v3, s[30:31] offset:0
    global_load_ushort v32, v4, s[18:19] offset:0
    global_load_ushort v33, v4, s[20:21] offset:0
    global_load_ushort v34, v4, s[22:23] offset:0
    global_load_ushort v35, v4, s[24:25] offset:0
    global_load_ushort v36, v4, s[26:27] offset:0
    global_load_ushort v37, v4, s[28:29] offset:0
    global_load_ushort v198, v3, s[30:31] offset:2
    global_load_ushort v192, v4, s[18:19] offset:256
    global_load_ushort v193, v4, s[20:21] offset:256
    global_load_ushort v194, v4, s[22:23] offset:256
    global_load_ushort v195, v4, s[24:25] offset:256
    global_load_ushort v196, v4, s[26:27] offset:256
    global_load_ushort v197, v4, s[28:29] offset:256
    s_barrier
    s_mov_b32 s64, s46
    s_and_b32 s65, s47, 0xffff
    s_mov_b32 s66, 0x10000000
    s_mov_b32 s67, 0x20000
    s_lshl_b32 s69, s54, 8
    s_add_u32 s69, s69, 123200
    v_lshlrev_b32 v5, 2, v0
    v_add_u32 v5, s69, v5
    v_and_b32 v16, 15, v0
    v_lshrrev_b32 v3, 4, v0
    v_mul_u32_u24 v6, 544, v16
    v_lshl_add_u32 v6, v3, 4, v6
    v_add_u32 v6, 123200, v6
    v_lshrrev_b32 v7, 2, v16
    v_lshlrev_b32 v7, 1, v7
    v_and_b32 v9, 1, v16
    v_add3_u32 v7, v7, v9, 32
    v_cmp_eq_u32 vcc, 2, v16
    v_mov_b32 v9, 40
    s_mul_i32 s10, s3, 8704
    v_cndmask_b32 v7, v7, v9, vcc
    v_mul_u32_u24 v7, 544, v7
    v_lshl_add_u32 v7, v3, 4, v7
    v_add_u32 v7, 123200, v7
    v_add_u32 v4, s10, v6
    s_cmp_eq_u32 s3, 2
    s_cselect_b64 vcc, -1, 0
    v_lshlrev_b32 v11, 4, v16
    v_lshrrev_b32 v9, 1, v3
    v_cndmask_b32 v7, v4, v7, vcc
    v_lshlrev_b32 v9, 8, v9
    v_and_b32 v10, 1, v3
    v_lshl_add_u32 v9, v10, 3, v9
    v_add_u32 v9, v9, v11
    v_sub_u32 v9, 154208, v9
    v_lshl_add_u32 v10, v3, 8, v11
    v_sub_u32 v10, 154208, v10
    s_lshl_b32 s11, s3, 10
    s_add_u32 s12, s11, 154208
    v_add_u32 v12, s12, v2
    v_mov_b32 v14, 1
    s_mov_b32 s68, 0x3fb8aa3b
    s_mov_b32 s69, 0x32a57060
    s_mov_b32 s58, 4
    s_mov_b32 s59, 0
    s_waitcnt vmcnt(7)
KG_LOOP:
    v_lshlrev_b32 v32, 16, v32
    v_lshlrev_b32 v33, 16, v33
    v_lshlrev_b32 v34, 16, v34
    v_lshlrev_b32 v35, 16, v35
    v_lshlrev_b32 v36, 16, v36
    v_lshlrev_b32 v37, 16, v37
    v_lshlrev_b32 v38, 16, v38
    v_mul_f32 v39, s68, v38
    v_fma_f32 v40, v38, s68, -v39
    v_fma_f32 v40, v38, s69, v40
    v_exp_f32 v39, v39
    v_mul_f32 v40, 0x3f317218, v40
    s_nop 0
    v_fma_f32 v39, v39, v40, v39
    v_cvt_pk_bf16_f32 v39, 0, v39
    v_mul_f32 v32, v39, v32
    v_mul_f32 v33, v39, v33
    v_mul_f32 v34, v39, v34
    v_mul_f32 v35, v39, v35
    v_mul_f32 v32, s68, v32
    v_mul_f32 v33, 0.15915494, v33
    v_pk_mul_f32 v[48:49], v[36:37], v[34:35] op_sel:[0,0] op_sel_hi:[1,0]
    v_pk_fma_f32 v[48:49], v[36:37], v[34:35], v[48:49] op_sel:[1,1,0] op_sel_hi:[0,1,1] neg_lo:[1,0,0]
    s_cmp_eq_u32 s55, 0
    s_cbranch_scc0 KG_E1
    v_mul_f32 v40, 0x3f800000, v32
    v_mul_f32 v41, 0x3f800000, v33
    v_mul_f32 v42, 0x43000000, v32
    v_mul_f32 v43, 0x43000000, v33
    v_exp_f32 v40, v40
    v_fract_f32 v41, v41
    v_exp_f32 v42, v42
    v_fract_f32 v43, v43
    v_cos_f32 v58, v41
    v_sin_f32 v59, v41
    v_cos_f32 v50, v43
    v_sin_f32 v51, v43
    s_nop 0
    v_pk_mul_f32 v[58:59], v[58:59], v[40:41] op_sel_hi:[1,0]
    v_pk_mul_f32 v[50:51], v[50:51], v[42:43] op_sel_hi:[1,0]
    v_cvt_pk_bf16_f32 v112, v48, v49
    v_pk_mul_f32 v[60:61], v[58:59], v[58:59] op_sel:[0,0] op_sel_hi:[1,0]
    v_pk_mul_f32 v[72:73], v[48:49], v[50:51] op_sel:[0,0] op_sel_hi:[1,0]
    ds_write_b32 v5, v112 offset:0
    v_pk_fma_f32 v[60:61], v[58:59], v[58:59], v[60:61] op_sel:[1,1,0] op_sel_hi:[0,1,1] neg_lo:[1,0,0]
    v_pk_fma_f32 v[72:73], v[48:49], v[50:51], v[72:73] op_sel:[1,1,0] op_sel_hi:[0,1,1] neg_lo:[1,0,0]
    v_pk_mul_f32 v[80:81], v[48:49], v[58:59] op_sel:[0,0] op_sel_hi:[1,0]
    v_pk_mul_f32 v[62:63], v[60:61], v[58:59] op_sel:[0,0] op_sel_hi:[1,0]
    v_pk_mul_f32 v[64:65], v[60:61], v[60:61] op_sel:[0,0] op_sel_hi:[1,0]
    v_pk_mul_f32 v[74:75], v[72:73], v[50:51] op_sel:[0,0] op_sel_hi:[1,0]
    v_pk_fma_f32 v[62:63], v[60:61], v[58:59], v[62:63] op_sel:[1,1,0] op_sel_hi:[0,1,1] neg_lo:[1,0,0]
    v_pk_fma_f32 v[64:65], v[60:61], v[60:61], v[64:65] op_sel:[1,1,0] op_sel_hi:[0,1,1] neg_lo:[1,0,0]
    v_pk_fma_f32 v[74:75], v[72:73], v[50:51], v[74:75] op_sel:[1,1,0] op_sel_hi:[0,1,1] neg_lo:[1,0,0]
    v_pk_mul_f32 v[68:69], v[62:63], v[62:63] op_sel:[0,0] op_sel_hi:[1,0]
    v_pk_mul_f32 v[66:67], v[64:65], v[58:59] op_sel:[0,0] op_sel_hi:[1,0]
    v_pk_mul_f32 v[70:71], v[64:65], v[62:63] op_sel:[0,0] op_sel_hi:[1,0]
    v_pk_fma_f32 v[68:69], v[62:63], v[62:63], v[68:69] op_sel:[1,1,0] op_sel_hi:[0,1,1] neg_lo:[1,0,0]
    v_pk_fma_f32 v[66:67], v[64:65], v[58:59], v[66:67] op_sel:[1,1,0] op_sel_hi:[0,1,1] neg_lo:[1,0,0]
    v_pk_fma_f32 v[70:71], v[64:65], v[62:63], v[70:71] op_sel:[1,1,0] op_sel_hi:[0,1,1] neg_lo:[1,0,0]
    v_pk_mul_f32 v[76:77], v[74:75], v[50:51] op_sel:[0,0] op_sel_hi:[1,0]
    v_pk_fma_f32 v[80:81], v[48:49], v[58:59], v[80:81] op_sel:[1,1,0] op_sel_hi:[0,1,1] neg_lo:[1,0,0]
    v_pk_mul_f32 v[82:83], v[48:49], v[60:61] op_sel:[0,0] op_sel_hi:[1,0]
    v_pk_fma_f32 v[76:77], v[74:75], v[50:51], v[76:77] op_sel:[1,1,0] op_sel_hi:[0,1,1] neg_lo:[1,0,0]
    v_cvt_pk_bf16_f32 v113, v80, v81
    v_pk_fma_f32 v[82:83], v[48:49], v[60:61], v[82:83] op_sel:[1,1,0] op_sel_hi:[0,1,1] neg_lo:[1,0,0]
    v_pk_mul_f32 v[84:85], v[48:49], v[62:63] op_sel:[0,0] op_sel_hi:[1,0]
    ds_write_b32 v5, v113 offset:544
    v_cvt_pk_bf16_f32 v114, v82, v83
    v_pk_fma_f32 v[84:85], v[48:49], v[62:63], v[84:85] op_sel:[1,1,0] op_sel_hi:[0,1,1] neg_lo:[1,0,0]
    v_pk_mul_f32 v[86:87], v[48:49], v[64:65] op_sel:[0,0] op_sel_hi:[1,0]
    ds_write_b32 v5, v114 offset:1088
    v_cvt_pk_bf16_f32 v115, v84, v85
    v_pk_fma_f32 v[86:87], v[48:49], v[64:65], v[86:87] op_sel:[1,1,0] op_sel_hi:[0,1,1] neg_lo:[1,0,0]
    v_pk_mul_f32 v[88:89], v[48:49], v[66:67] op_sel:[0,0] op_sel_hi:[1,0]
    ds_write_b32 v5, v115 offset:1632
    v_cvt_pk_bf16_f32 v116, v86, v87
    v_pk_fma_f32 v[88:89], v[48:49], v[66:67], v[88:89] op_sel:[1,1,0] op_sel_hi:[0,1,1] neg_lo:[1,0,0]
    v_pk_mul_f32 v[90:91], v[48:49], v[68:69] op_sel:[0,0] op_sel_hi:[1,0]
    ds_write_b32 v5, v116 offset:2176
    v_cvt_pk_bf16_f32 v117, v88, v89
    v_pk_fma_f32 v[90:91], v[48:49], v[68:69], v[90:91] op_sel:[1,1,0] op_sel_hi:[0,1,1] neg_lo:[1,0,0]
    v_pk_mul_f32 v[92:93], v[48:49], v[70:71] op_sel:[0,0] op_sel_hi:[1,0]
    ds_write_b32 v5, v117 offset:2720
    v_cvt_pk_bf16_f32 v118, v90, v91
    v_pk_fma_f32 v[92:93], v[48:49], v[70:71], v[92:93] op_sel:[1,1,0] op_sel_hi:[0,1,1] neg_lo:[1,0,0]
    v_cvt_pk_bf16_f32 v120, v72, v73
    ds_write_b32 v5, v118 offset:3264
    v_cvt_pk_bf16_f32 v119, v92, v93
    v_pk_mul_f32 v[94:95], v[72:73], v[58:59] op_sel:[0,0] op_sel_hi:[1,0]
    ds_write_b32 v5, v120 offset:4352
    v_pk_mul_f32 v[96:97], v[72:73], v[60:61] op_sel:[0,0] op_sel_hi:[1,0]
    v_pk_fma_f32 v[94:95], v[72:73], v[58:59], v[94:95] op_sel:[1,1,0] op_sel_hi:[0,1,1] neg_lo:[1,0,0]
    ds_write_b32 v5, v119 offset:3808
    v_pk_fma_f32 v[96:97], v[72:73], v[60:61], v[96:97] op_sel:[1,1,0] op_sel_hi:[0,1,1] neg_lo:[1,0,0]
    v_cvt_pk_bf16_f32 v121, v94, v95
    v_pk_mul_f32 v[98:99], v[72:73], v[62:63] op_sel:[0,0] op_sel_hi:[1,0]
    v_cvt_pk_bf16_f32 v122, v96, v97
    ds_write_b32 v5, v121 offset:4896
    v_pk_fma_f32 v[98:99], v[72:73], v[62:63], v[98:99] op_sel:[1,1,0] op_sel_hi:[0,1,1] neg_lo:[1,0,0]
    v_pk_mul_f32 v[100:101], v[72:73], v[64:65] op_sel:[0,0] op_sel_hi:[1,0]
    ds_write_b32 v5, v122 offset:5440
    v_cvt_pk_bf16_f32 v123, v98, v99
    v_pk_fma_f32 v[100:101], v[72:73], v[64:65], v[100:101] op_sel:[1,1,0] op_sel_hi:[0,1,1] neg_lo:[1,0,0]
    v_pk_mul_f32 v[102:103], v[72:73], v[66:67] op_sel:[0,0] op_sel_hi:[1,0]
    ds_write_b32 v5, v123 offset:5984
    v_cvt_pk_bf16_f32 v112, v100, v101
    v_pk_fma_f32 v[102:103], v[72:73], v[66:67], v[102:103] op_sel:[1,1,0] op_sel_hi:[0,1,1] neg_lo:[1,0,0]
    v_pk_mul_f32 v[80:81], v[72:73], v[68:69] op_sel:[0,0] op_sel_hi:[1,0]
    ds_write_b32 v5, v112 offset:6528
    v_cvt_pk_bf16_f32 v113, v102, v103
    v_pk_fma_f32 v[80:81], v[72:73], v[68:69], v[80:81] op_sel:[1,1,0] op_sel_hi:[0,1,1] neg_lo:[1,0,0]
    v_pk_mul_f32 v[82:83], v[72:73], v[70:71] op_sel:[0,0] op_sel_hi:[1,0]
    ds_write_b32 v5, v113 offset:7072
    v_cvt_pk_bf16_f32 v114, v80, v81
    v_pk_fma_f32 v[82:83], v[72:73], v[70:71], v[82:83] op_sel:[1,1,0] op_sel_hi:[0,1,1] neg_lo:[1,0,0]
    v_cvt_pk_bf16_f32 v116, v74, v75
    ds_write_b32 v5, v114 offset:7616
    v_cvt_pk_bf16_f32 v115, v82, v83
    v_pk_mul_f32 v[84:85], v[74:75], v[60:61] op_sel:[0,0] op_sel_hi:[1,0]
    ds_write_b32 v5, v116 offset:8704
    v_pk_mul_f32 v[86:87], v[74:75], v[64:65] op_sel:[0,0] op_sel_hi:[1,0]
    v_pk_fma_f32 v[84:85], v[74:75], v[60:61], v[84:85] op_sel:[1,1,0] op_sel_hi:[0,1,1] neg_lo:[1,0,0]
    ds_write_b32 v5, v115 offset:8160
    v_pk_fma_f32 v[86:87], v[74:75], v[64:65], v[86:87] op_sel:[1,1,0] op_sel_hi:[0,1,1] neg_lo:[1,0,0]
    v_cvt_pk_bf16_f32 v117, v84, v85
    v_pk_mul_f32 v[88:89], v[74:75], v[68:69] op_sel:[0,0] op_sel_hi:[1,0]
    v_cvt_pk_bf16_f32 v118, v86, v87
    ds_write_b32 v5, v117 offset:9248
    v_pk_fma_f32 v[88:89], v[74:75], v[68:69], v[88:89] op_sel:[1,1,0] op_sel_hi:[0,1,1] neg_lo:[1,0,0]
    v_cvt_pk_bf16_f32 v120, v76, v77
    ds_write_b32 v5, v118 offset:10880
    v_cvt_pk_bf16_f32 v119, v88, v89
    v_pk_mul_f32 v[90:91], v[76:77], v[60:61] op_sel:[0,0] op_sel_hi:[1,0]
    ds_write_b32 v5, v120 offset:13056
    v_pk_mul_f32 v[92:93], v[76:77], v[64:65] op_sel:[0,0] op_sel_hi:[1,0]
    v_pk_fma_f32 v[90:91], v[76:77], v[60:61], v[90:91] op_sel:[1,1,0] op_sel_hi:[0,1,1] neg_lo:[1,0,0]
    ds_write_b32 v5, v119 offset:11424
    v_pk_fma_f32 v[92:93], v[76:77], v[64:65], v[92:93] op_sel:[1,1,0] op_sel_hi:[0,1,1] neg_lo:[1,0,0]
    v_cvt_pk_bf16_f32 v121, v90, v91
    v_pk_mul_f32 v[94:95], v[76:77], v[68:69] op_sel:[0,0] op_sel_hi:[1,0]
    v_cvt_pk_bf16_f32 v122, v92, v93
    ds_write_b32 v5, v121 offset:13600
    v_pk_fma_f32 v[94:95], v[76:77], v[68:69], v[94:95] op_sel:[1,1,0] op_sel_hi:[0,1,1] neg_lo:[1,0,0]
    ds_write_b32 v5, v122 offset:15232
    v_cvt_pk_bf16_f32 v123, v94, v95
    ds_write_b32 v5, v123 offset:15776
    s_branch KG_TDONE
KG_E1:
    v_mul_f32 v40, 0x41000000, v32
    v_mul_f32 v41, 0x41000000, v33
    v_mul_f32 v42, 0x43000000, v32
    v_mul_f32 v43, 0x43000000, v33
    v_mul_f32 v44, 0x40800000, v32
    v_mul_f32 v45, 0x40800000, v33
    v_mul_f32 v46, 0x44000000, v32
    v_mul_f32 v47, 0x44000000, v33
    v_exp_f32 v40, v40
    v_fract_f32 v41, v41
    v_exp_f32 v42, v42
    v_fract_f32 v43, v43
    v_exp_f32 v44, v44
    v_fract_f32 v45, v45
    v_exp_f32 v46, v46
    v_fract_f32 v47, v47
    v_cos_f32 v52, v41
    v_sin_f32 v53, v41
    v_cos_f32 v50, v43
    v_sin_f32 v51, v43
    v_cos_f32 v54, v45
    v_sin_f32 v55, v45
    v_cos_f32 v56, v47
    v_sin_f32 v57, v47
    s_nop 0
    v_pk_mul_f32 v[52:53], v[52:53], v[40:41] op_sel_hi:[1,0]
    v_pk_mul_f32 v[50:51], v[50:51], v[42:43] op_sel_hi:[1,0]
    v_pk_mul_f32 v[54:55], v[54:55], v[44:45] op_sel_hi:[1,0]
    v_pk_mul_f32 v[56:57], v[56:57], v[46:47] op_sel_hi:[1,0]
    v_mov_b32 v61, 0x3f80
    ds_write_b32 v5, v61 offset:22304
    v_pk_mul_f32 v[58:59], v[48:49], v[56:57] op_sel:[0,0] op_sel_hi:[1,0]
    v_cvt_pk_bf16_f32 v112, v52, -v53
    v_pk_mul_f32 v[70:71], v[52:53], v[52:53] op_sel:[0,0] op_sel_hi:[1,0]
    v_pk_fma_f32 v[58:59], v[48:49], v[56:57], v[58:59] op_sel:[1,1,0] op_sel_hi:[0,1,1] neg_lo:[1,0,0]
    ds_write_b32 v5, v112 offset:22848
    v_pk_fma_f32 v[70:71], v[52:53], v[52:53], v[70:71] op_sel:[1,1,0] op_sel_hi:[0,1,1] neg_lo:[1,0,0]
    v_pk_mul_f32 v[60:61], v[58:59], v[50:51] op_sel:[0,0] op_sel_hi:[1,0]
    v_cvt_pk_bf16_f32 v114, v58, v59
    v_cvt_pk_bf16_f32 v113, v70, -v71
    v_pk_fma_f32 v[60:61], v[58:59], v[50:51], v[60:61] op_sel:[1,1,0] op_sel_hi:[0,1,1] neg_lo:[1,0,0]
    ds_write_b32 v5, v114 offset:9792
    v_pk_mul_f32 v[74:75], v[58:59], v[54:55] op_sel:[0,0] op_sel_hi:[1,0]
    v_pk_mul_f32 v[62:63], v[60:61], v[50:51] op_sel:[0,0] op_sel_hi:[1,0]
    ds_write_b32 v5, v113 offset:23392
    v_pk_fma_f32 v[74:75], v[58:59], v[54:55], v[74:75] op_sel:[1,1,0] op_sel_hi:[0,1,1] neg_lo:[1,0,0]
    v_pk_fma_f32 v[62:63], v[60:61], v[50:51], v[62:63] op_sel:[1,1,0] op_sel_hi:[0,1,1] neg_lo:[1,0,0]
    v_pk_mul_f32 v[72:73], v[70:71], v[52:53] op_sel:[0,0] op_sel_hi:[1,0]
    v_cvt_pk_bf16_f32 v115, v74, v75
    v_cvt_pk_bf16_f32 v117, v60, v61
    v_pk_fma_f32 v[72:73], v[70:71], v[52:53], v[72:73] op_sel:[1,1,0] op_sel_hi:[0,1,1] neg_lo:[1,0,0]
    ds_write_b32 v5, v115 offset:10336
    v_pk_mul_f32 v[76:77], v[60:61], v[54:55] op_sel:[0,0] op_sel_hi:[1,0]
    v_cvt_pk_bf16_f32 v116, v72, -v73
    ds_write_b32 v5, v117 offset:11968
    v_pk_fma_f32 v[76:77], v[60:61], v[54:55], v[76:77] op_sel:[1,1,0] op_sel_hi:[0,1,1] neg_lo:[1,0,0]
    v_pk_mul_f32 v[64:65], v[62:63], v[50:51] op_sel:[0,0] op_sel_hi:[1,0]
    ds_write_b32 v5, v116 offset:23936
    v_cvt_pk_bf16_f32 v118, v76, v77
    v_pk_fma_f32 v[64:65], v[62:63], v[50:51], v[64:65] op_sel:[1,1,0] op_sel_hi:[0,1,1] neg_lo:[1,0,0]
    v_pk_mul_f32 v[66:67], v[72:73], v[52:53] op_sel:[0,0] op_sel_hi:[1,0]
    ds_write_b32 v5, v118 offset:12512
    v_cvt_pk_bf16_f32 v120, v62, v63
    v_pk_fma_f32 v[66:67], v[72:73], v[52:53], v[66:67] op_sel:[1,1,0] op_sel_hi:[0,1,1] neg_lo:[1,0,0]
    v_pk_mul_f32 v[78:79], v[62:63], v[54:55] op_sel:[0,0] op_sel_hi:[1,0]
    ds_write_b32 v5, v120 offset:14144
    v_cvt_pk_bf16_f32 v119, v66, -v67
    v_pk_fma_f32 v[78:79], v[62:63], v[54:55], v[78:79] op_sel:[1,1,0] op_sel_hi:[0,1,1] neg_lo:[1,0,0]
    v_pk_mul_f32 v[58:59], v[64:65], v[50:51] op_sel:[0,0] op_sel_hi:[1,0]
    ds_write_b32 v5, v119 offset:24480
    v_cvt_pk_bf16_f32 v121, v78, v79
    v_pk_fma_f32 v[58:59], v[64:65], v[50:51], v[58:59] op_sel:[1,1,0] op_sel_hi:[0,1,1] neg_lo:[1,0,0]
    v_pk_mul_f32 v[68:69], v[66:67], v[52:53] op_sel:[0,0] op_sel_hi:[1,0]
    ds_write_b32 v5, v121 offset:14688
    v_cvt_pk_bf16_f32 v123, v64, v65
    v_pk_fma_f32 v[68:69], v[66:67], v[52:53], v[68:69] op_sel:[1,1,0] op_sel_hi:[0,1,1] neg_lo:[1,0,0]
    v_pk_mul_f32 v[80:81], v[64:65], v[54:55] op_sel:[0,0] op_sel_hi:[1,0]
    ds_write_b32 v5, v123 offset:16320
    v_cvt_pk_bf16_f32 v122, v68, -v69
    v_pk_fma_f32 v[80:81], v[64:65], v[54:55], v[80:81] op_sel:[1,1,0] op_sel_hi:[0,1,1] neg_lo:[1,0,0]
    v_pk_mul_f32 v[60:61], v[58:59], v[50:51] op_sel:[0,0] op_sel_hi:[1,0]
    ds_write_b32 v5, v122 offset:25024
    v_cvt_pk_bf16_f32 v112, v80, v81
    v_pk_fma_f32 v[60:61], v[58:59], v[50:51], v[60:61] op_sel:[1,1,0] op_sel_hi:[0,1,1] neg_lo:[1,0,0]
    v_pk_mul_f32 v[70:71], v[68:69], v[52:53] op_sel:[0,0] op_sel_hi:[1,0]
    ds_write_b32 v5, v112 offset:16864
    v_cvt_pk_bf16_f32 v114, v58, v59
    v_pk_fma_f32 v[70:71], v[68:69], v[52:53], v[70:71] op_sel:[1,1,0] op_sel_hi:[0,1,1] neg_lo:[1,0,0]
    v_pk_mul_f32 v[62:63], v[60:61], v[50:51] op_sel:[0,0] op_sel_hi:[1,0]
    ds_write_b32 v5, v114 offset:17408
    v_cvt_pk_bf16_f32 v113, v70, -v71
    v_pk_fma_f32 v[62:63], v[60:61], v[50:51], v[62:63] op_sel:[1,1,0] op_sel_hi:[0,1,1] neg_lo:[1,0,0]
    v_pk_mul_f32 v[72:73], v[70:71], v[52:53] op_sel:[0,0] op_sel_hi:[1,0]
    ds_write_b32 v5, v113 offset:25568
    v_cvt_pk_bf16_f32 v116, v60, v61
    v_pk_fma_f32 v[72:73], v[70:71], v[52:53], v[72:73] op_sel:[1,1,0] op_sel_hi:[0,1,1] neg_lo:[1,0,0]
    v_pk_mul_f32 v[64:65], v[62:63], v[50:51] op_sel:[0,0] op_sel_hi:[1,0]
    ds_write_b32 v5, v116 offset:18496
    v_cvt_pk_bf16_f32 v115, v72, -v73
    v_pk_fma_f32 v[64:65], v[62:63], v[50:51], v[64:65] op_sel:[1,1,0] op_sel_hi:[0,1,1] neg_lo:[1,0,0]
    v_pk_mul_f32 v[66:67], v[72:73], v[52:53] op_sel:[0,0] op_sel_hi:[1,0]
    ds_write_b32 v5, v115 offset:26112
    v_cvt_pk_bf16_f32 v118, v62, v63
    v_pk_fma_f32 v[66:67], v[72:73], v[52:53], v[66:67] op_sel:[1,1,0] op_sel_hi:[0,1,1] neg_lo:[1,0,0]
    v_pk_mul_f32 v[58:59], v[64:65], v[50:51] op_sel:[0,0] op_sel_hi:[1,0]
    ds_write_b32 v5, v118 offset:19584
    v_cvt_pk_bf16_f32 v117, v66, -v67
    v_pk_fma_f32 v[58:59], v[64:65], v[50:51], v[58:59] op_sel:[1,1,0] op_sel_hi:[0,1,1] neg_lo:[1,0,0]
    v_pk_mul_f32 v[68:69], v[66:67], v[52:53] op_sel:[0,0] op_sel_hi:[1,0]
    ds_write_b32 v5, v117 offset:26656
    v_cvt_pk_bf16_f32 v120, v64, v65
    v_pk_fma_f32 v[68:69], v[66:67], v[52:53], v[68:69] op_sel:[1,1,0] op_sel_hi:[0,1,1] neg_lo:[1,0,0]
    v_pk_mul_f32 v[60:61], v[58:59], v[50:51] op_sel:[0,0] op_sel_hi:[1,0]
    ds_write_b32 v5, v120 offset:20672
    v_cvt_pk_bf16_f32 v119, v68, -v69
    v_pk_fma_f32 v[60:61], v[58:59], v[50:51], v[60:61] op_sel:[1,1,0] op_sel_hi:[0,1,1] neg_lo:[1,0,0]
    v_pk_mul_f32 v[70:71], v[68:69], v[52:53] op_sel:[0,0] op_sel_hi:[1,0]
    ds_write_b32 v5, v119 offset:27200
    v_cvt_pk_bf16_f32 v122, v58, v59
    v_pk_fma_f32 v[70:71], v[68:69], v[52:53], v[70:71] op_sel:[1,1,0] op_sel_hi:[0,1,1] neg_lo:[1,0,0]
    v_pk_mul_f32 v[62:63], v[60:61], v[50:51] op_sel:[0,0] op_sel_hi:[1,0]
    ds_write_b32 v5, v122 offset:17952
    v_cvt_pk_bf16_f32 v121, v70, -v71
    v_pk_fma_f32 v[62:63], v[60:61], v[50:51], v[62:63] op_sel:[1,1,0] op_sel_hi:[0,1,1] neg_lo:[1,0,0]
    v_pk_mul_f32 v[72:73], v[70:71], v[52:53] op_sel:[0,0] op_sel_hi:[1,0]
    ds_write_b32 v5, v121 offset:27744
    v_cvt_pk_bf16_f32 v112, v60, v61
    v_pk_fma_f32 v[72:73], v[70:71], v[52:53], v[72:73] op_sel:[1,1,0] op_sel_hi:[0,1,1] neg_lo:[1,0,0]
    v_pk_mul_f32 v[64:65], v[62:63], v[50:51] op_sel:[0,0] op_sel_hi:[1,0]
    ds_write_b32 v5, v112 offset:19040
    v_cvt_pk_bf16_f32 v123, v72, -v73
    v_pk_fma_f32 v[64:65], v[62:63], v[50:51], v[64:65] op_sel:[1,1,0] op_sel_hi:[0,1,1] neg_lo:[1,0,0]
    v_pk_mul_f32 v[66:67], v[72:73], v[52:53] op_sel:[0,0] op_sel_hi:[1,0]
    ds_write_b32 v5, v123 offset:28288
    v_cvt_pk_bf16_f32 v114, v62, v63
    v_pk_fma_f32 v[66:67], v[72:73], v[52:53], v[66:67] op_sel:[1,1,0] op_sel_hi:[0,1,1] neg_lo:[1,0,0]
    v_pk_mul_f32 v[58:59], v[64:65], v[50:51] op_sel:[0,0] op_sel_hi:[1,0]
    ds_write_b32 v5, v114 offset:20128
    v_cvt_pk_bf16_f32 v113, v66, -v67
    v_pk_fma_f32 v[58:59], v[64:65], v[50:51], v[58:59] op_sel:[1,1,0] op_sel_hi:[0,1,1] neg_lo:[1,0,0]
    v_pk_mul_f32 v[68:69], v[66:67], v[52:53] op_sel:[0,0] op_sel_hi:[1,0]
    ds_write_b32 v5, v113 offset:28832
    v_cvt_pk_bf16_f32 v116, v64, v65
    v_pk_fma_f32 v[68:69], v[66:67], v[52:53], v[68:69] op_sel:[1,1,0] op_sel_hi:[0,1,1] neg_lo:[1,0,0]
    v_cvt_pk_bf16_f32 v118, v58, v59
    ds_write_b32 v5, v116 offset:21216
    v_cvt_pk_bf16_f32 v115, v68, -v69
    v_pk_mul_f32 v[70:71], v[68:69], v[52:53] op_sel:[0,0] op_sel_hi:[1,0]
    ds_write_b32 v5, v118 offset:21760
    ds_write_b32 v5, v115 offset:29376
    v_pk_fma_f32 v[70:71], v[68:69], v[52:53], v[70:71] op_sel:[1,1,0] op_sel_hi:[0,1,1] neg_lo:[1,0,0]
    v_cvt_pk_bf16_f32 v117, v70, -v71
    ds_write_b32 v5, v117 offset:29920
    v_pk_mul_f32 v[72:73], v[70:71], v[52:53] op_sel:[0,0] op_sel_hi:[1,0]
    v_pk_fma_f32 v[72:73], v[70:71], v[52:53], v[72:73] op_sel:[1,1,0] op_sel_hi:[0,1,1] neg_lo:[1,0,0]
    v_cvt_pk_bf16_f32 v119, v72, -v73
    ds_write_b32 v5, v119 offset:30464
KG_TDONE:
    s_waitcnt lgkmcnt(0)
    s_mov_b64 exec, 1
    ds_add_u32 v13, v14 offset:0
    s_mov_b64 exec, -1
SPIN_1:
    ds_read_b32 v15, v13 offset:0
    s_waitcnt lgkmcnt(0)
    v_readfirstlane_b32 s15, v15
    s_cmp_ge_u32 s15, s58
    s_cbranch_scc0 SPIN_1
    s_add_u32 s58, s58, 4
    s_cmp_eq_u32 s3, 3
    s_cbranch_scc1 KG_SCD
    ds_read_b128 v[32:35], v6 offset:22304
    ds_read_b128 v[64:67], v7 offset:0
    ds_read_b128 v[36:39], v6 offset:22368
    ds_read_b128 v[68:71], v7 offset:64
    ds_read_b128 v[40:43], v6 offset:22432
    ds_read_b128 v[72:75], v7 offset:128
    ds_read_b128 v[44:47], v6 offset:22496
    ds_read_b128 v[76:79], v7 offset:192
    ds_read_b128 v[48:51], v6 offset:22560
    ds_read_b128 v[80:83], v7 offset:256
    ds_read_b128 v[52:55], v6 offset:22624
    ds_read_b128 v[84:87], v7 offset:320
    ds_read_b128 v[56:59], v6 offset:22688
    ds_read_b128 v[88:91], v7 offset:384
    ds_read_b128 v[60:63], v6 offset:22752
    ds_read_b128 v[92:95], v7 offset:448
    s_waitcnt lgkmcnt(14)
    v_mfma_f32_16x16x32_bf16 v[16:19], v[64:67], v[32:35], 0
    s_waitcnt lgkmcnt(12)
    v_mfma_f32_16x16x32_bf16 v[16:19], v[68:71], v[36:39], v[16:19]
    s_waitcnt lgkmcnt(10)
    v_mfma_f32_16x16x32_bf16 v[16:19], v[72:75], v[40:43], v[16:19]
    s_waitcnt lgkmcnt(8)
    v_mfma_f32_16x16x32_bf16 v[16:19], v[76:79], v[44:47], v[16:19]
    s_waitcnt lgkmcnt(6)
    v_mfma_f32_16x16x32_bf16 v[16:19], v[80:83], v[48:51], v[16:19]
    s_waitcnt lgkmcnt(4)
    v_mfma_f32_16x16x32_bf16 v[16:19], v[84:87], v[52:55], v[16:19]
    s_waitcnt lgkmcnt(2)
    v_mfma_f32_16x16x32_bf16 v[16:19], v[88:91], v[56:59], v[16:19]
    s_waitcnt lgkmcnt(0)
    v_mfma_f32_16x16x32_bf16 v[16:19], v[92:95], v[60:63], v[16:19]
    s_nop 6
    s_cmp_eq_u32 s3, 1
    v_cvt_pk_bf16_f32 v16, v16, v16
    v_cvt_pk_bf16_f32 v17, v17, v17
    v_cvt_pk_bf16_f32 v18, v18, v18
    v_cvt_pk_bf16_f32 v19, v19, v19
    s_cbranch_scc1 KG_T1
    s_cmp_eq_u32 s3, 2
    s_cbranch_scc1 KG_T2
    ds_write_b16 v9, v16 offset:4094
    ds_write_b16 v9, v17 offset:4092
    ds_write_b16 v9, v18 offset:4090
    ds_write_b16 v9, v19 offset:4088
    s_branch KG_SCD
KG_T1:
    ds_write_b16 v10, v18 offset:3072
    ds_write_b16 v10, v18 offset:3070
    ds_write_b16 v10, v18 offset:3068
    ds_write_b16 v10, v18 offset:3066
    ds_write_b16 v10, v19 offset:3064
    ds_write_b16 v10, v19 offset:3062
    ds_write_b16 v10, v19 offset:3060
    ds_write_b16 v9, v16 offset:3582
    ds_write_b16 v9, v16 offset:3580
    ds_write_b16 v9, v17 offset:3578
    s_mov_b64 exec, -2
    ds_write_b16 v10, v18 offset:3074
    ds_write_b16 v9, v16 offset:3584
    s_branch KG_SCD
KG_T2:
    v_mov_b32 v20, v16
    v_mov_b32 v21, v16
    v_mov_b32 v22, v17
    v_mov_b32 v23, v17
    ds_write_b64 v10, v[20:21] offset:2040
    ds_write_b32 v10, v20 offset:2048
    ds_write_b64 v10, v[22:23] offset:1016
    ds_write_b32 v10, v22 offset:1024
    ds_write_b16 v10, v17 offset:1028
    s_mov_b64 exec, -2
    ds_write_b16 v10, v16 offset:2052
    s_mov_b32 exec_lo, 0x55555555
    s_mov_b32 exec_hi, 0x55555555
    ds_write_b16 v10, v16 offset:2038
    ds_write_b16 v10, v17 offset:1030
    ds_write_b16 v10, v17 offset:1014
    s_mov_b32 exec_lo, 0x55555554
    ds_write_b16 v10, v16 offset:2054
    s_mov_b64 exec, 1
    v_mov_b32 v21, v18
    v_mov_b32 v20, v18
    ds_write_b64 v10, v[20:21] offset:0
KG_SCD:
    s_mov_b64 exec, -1
    s_waitcnt lgkmcnt(0)
    s_mov_b64 exec, 1
    ds_add_u32 v13, v14 offset:0
    s_mov_b64 exec, -1
SPIN_2:
    ds_read_b32 v15, v13 offset:0
    s_waitcnt lgkmcnt(0)
    v_readfirstlane_b32 s15, v15
    s_cmp_ge_u32 s15, s58
    s_cbranch_scc0 SPIN_2
    s_add_u32 s58, s58, 4
    ds_read_b128 v[204:207], v12
    s_add_u32 s59, s59, 1
    s_cmp_eq_u32 s59, 2
    s_waitcnt lgkmcnt(0) vmcnt(0)
    s_cbranch_scc1 KG_DONE
    v_mov_b32 v200, v204
    v_mov_b32 v201, v205
    v_mov_b32 v202, v206
    v_mov_b32 v203, v207
    v_mov_b32 v32, v192
    v_mov_b32 v33, v193
    v_mov_b32 v34, v194
    v_mov_b32 v35, v195
    v_mov_b32 v36, v196
    v_mov_b32 v37, v197
    v_mov_b32 v38, v198
    s_branch KG_LOOP
KG_DONE:
    s_mov_b64 exec, 1
    ds_add_u32 v13, v14 offset:0
    s_mov_b64 exec, -1
SPIN_3:
    ds_read_b32 v15, v13 offset:0
    s_waitcnt lgkmcnt(0)
    v_readfirstlane_b32 s15, v15
    s_cmp_ge_u32 s15, s58
    s_cbranch_scc0 SPIN_3
    s_add_u32 s58, s58, 4
    s_lshr_b32 s10, s2, 3
    s_lshl_b32 s10, s10, 2
    s_add_u32 s10, s10, s3
    s_mul_i32 s10, s10, 43
    v_min_u32 v24, 42, v0
    v_add_u32 v24, s10, v24
    v_lshrrev_b32 v25, 2, v24
    v_and_b32 v24, 3, v24
    v_lshlrev_b32 v25, 10, v25
    v_lshl_add_u32 v25, v24, 7, v25
    s_bfe_u32 s10, s2, 0x10001
    s_lshl_b32 s10, s10, 9
    v_add_u32 v25, s10, v25
    global_load_dword v104, v25, s[40:41]
    s_mov_b32 s8, s40
    s_and_b32 s9, s41, 0xffff
    s_mov_b32 s10, 0x158000
    s_mov_b32 s11, 0x20000
    s_mul_i32 s92, s3, 22
    s_cmp_eq_u32 s3, 3
    s_cselect_b32 s92, 65, s92
    v_lshrrev_b32 v6, 3, v0
    v_and_b32 v7, 7, v0
    v_lshrrev_b32 v60, 2, v0
    v_and_b32 v60, 4, v60
    v_xor_b32 v7, v7, v60
    v_lshlrev_b32 v60, 10, v6
    v_lshl_add_u32 v60, v7, 4, v60
    s_lshl_b32 s93, s92, 14
    s_lshl_b32 s94, s52, 7
    s_add_u32 s93, s93, s94
    s_lshl_b32 s94, s3, 11
    s_add_u32 s94, s94, 73920
    s_cmp_eq_u32 s49, 15
    s_cbranch_scc1 L_15
    s_cmp_ge_u32 s3, 2
    s_cselect_b32 s60, s38, s36
    s_cselect_b32 s61, s39, s37
    s_and_b32 s61, s61, 0xffff
    s_mov_b32 s62, 1409024
    s_mov_b32 s63, 0x20000
    v_mul_u32_u24 v20, 43, v0
    v_lshrrev_b32 v20, 9, v20
    v_mul_u32_u24 v21, 12, v20
    v_sub_u32 v21, v0, v21
    v_mul_u32_u24 v61, 2752, v20
    v_lshl_add_u32 v61, v21, 4, v61
    s_and_b32 s68, s3, 1
    s_mul_i32 s69, s68, 88064
    s_lshl_b32 s81, s50, 5
    s_add_u32 s69, s69, s81
    v_add_u32 v61, s69, v61
    s_mul_i32 s81, s68, 6144
    s_lshr_b32 s68, s3, 1
    s_mul_i32 s68, s68, 12320
    s_add_u32 s81, s81, s68
    s_mov_b32 s96, -1
    s_mov_b32 s97, 0xffff
    s_barrier
    s_mov_b32 s82, 880640
    s_add_u32 m0, s81, 0
    s_mov_b64 exec, s[96:97]
    buffer_load_dwordx4 v61, s[60:63], s82 offen lds
    s_add_u32 m0, m0, 768
    s_add_u32 s82, s82, 11008
    buffer_load_dwordx4 v61, s[60:63], s82 offen lds
    s_add_u32 m0, m0, 768
    s_add_u32 s82, s82, 11008
    buffer_load_dwordx4 v61, s[60:63], s82 offen lds
    s_add_u32 m0, m0, 768
    s_add_u32 s82, s82, 11008
    buffer_load_dwordx4 v61, s[60:63], s82 offen lds
    s_add_u32 m0, m0, 768
    s_add_u32 s82, s82, 11008
    buffer_load_dwordx4 v61, s[60:63], s82 offen lds
    s_add_u32 m0, m0, 768
    s_add_u32 s82, s82, 11008
    buffer_load_dwordx4 v61, s[60:63], s82 offen lds
    s_add_u32 m0, m0, 768
    s_add_u32 s82, s82, 11008
    buffer_load_dwordx4 v61, s[60:63], s82 offen lds
    s_add_u32 m0, m0, 768
    s_add_u32 s82, s82, 11008
    buffer_load_dwordx4 v61, s[60:63], s82 offen lds
    s_mov_b64 exec, -1
    s_barrier
    s_mov_b32 s82, 1056768
    s_add_u32 m0, s81, 24640
    s_mov_b64 exec, s[96:97]
    buffer_load_dwordx4 v61, s[60:63], s82 offen lds
    s_add_u32 m0, m0, 768
    s_add_u32 s82, s82, 11008
    buffer_load_dwordx4 v61, s[60:63], s82 offen lds
    s_add_u32 m0, m0, 768
    s_add_u32 s82, s82, 11008
    buffer_load_dwordx4 v61, s[60:63], s82 offen lds
    s_add_u32 m0, m0, 768
    s_add_u32 s82, s82, 11008
    buffer_load_dwordx4 v61, s[60:63], s82 offen lds
    s_add_u32 m0, m0, 768
    s_add_u32 s82, s82, 11008
    buffer_load_dwordx4 v61, s[60:63], s82 offen lds
    s_add_u32 m0, m0, 768
    s_add_u32 s82, s82, 11008
    buffer_load_dwordx4 v61, s[60:63], s82 offen lds
    s_add_u32 m0, m0, 768
    s_add_u32 s82, s82, 11008
    buffer_load_dwordx4 v61, s[60:63], s82 offen lds
    s_add_u32 m0, m0, 768
    s_add_u32 s82, s82, 11008
    buffer_load_dwordx4 v61, s[60:63], s82 offen lds
    s_mov_b64 exec, -1
    s_barrier
    s_mov_b32 s82, 1232896
    s_add_u32 m0, s81, 49280
    s_mov_b64 exec, s[96:97]
    buffer_load_dwordx4 v61, s[60:63], s82 offen lds
    s_add_u32 m0, m0, 768
    s_add_u32 s82, s82, 11008
    buffer_load_dwordx4 v61, s[60:63], s82 offen lds
    s_add_u32 m0, m0, 768
    s_add_u32 s82, s82, 11008
    buffer_load_dwordx4 v61, s[60:63], s82 offen lds
    s_add_u32 m0, m0, 768
    s_add_u32 s82, s82, 11008
    buffer_load_dwordx4 v61, s[60:63], s82 offen lds
    s_add_u32 m0, m0, 768
    s_add_u32 s82, s82, 11008
    buffer_load_dwordx4 v61, s[60:63], s82 offen lds
    s_add_u32 m0, m0, 768
    s_add_u32 s82, s82, 11008
    buffer_load_dwordx4 v61, s[60:63], s82 offen lds
    s_add_u32 m0, m0, 768
    s_add_u32 s82, s82, 11008
    buffer_load_dwordx4 v61, s[60:63], s82 offen lds
    s_add_u32 m0, m0, 768
    s_add_u32 s82, s82, 11008
    buffer_load_dwordx4 v61, s[60:63], s82 offen lds
    s_mov_b64 exec, -1
    s_waitcnt vmcnt(16)
    s_barrier
    s_waitcnt vmcnt(8)
    s_barrier
    s_waitcnt vmcnt(0)
    s_barrier
L_15:
    s_add_u32 m0, s94, 0
    s_add_u32 s7, s93, 0
    buffer_load_dwordx4 v60, s[8:11], s7 offen lds
    s_add_u32 m0, s94, 1024
    s_add_u32 s7, s93, 8192
    buffer_load_dwordx4 v60, s[8:11], s7 offen lds
    s_add_u32 m0, s94, 8192
    s_add_u32 s7, s93, 16384
    buffer_load_dwordx4 v60, s[8:11], s7 offen lds
    s_add_u32 m0, s94, 9216
    s_add_u32 s7, s93, 24576
    buffer_load_dwordx4 v60, s[8:11], s7 offen lds
    s_add_u32 m0, s94, 16384
    s_add_u32 s7, s93, 32768
    buffer_load_dwordx4 v60, s[8:11], s7 offen lds
    s_add_u32 m0, s94, 17408
    s_add_u32 s7, s93, 40960
    buffer_load_dwordx4 v60, s[8:11], s7 offen lds
    s_add_u32 m0, s94, 24576
    s_add_u32 s7, s93, 49152
    buffer_load_dwordx4 v60, s[8:11], s7 offen lds
    s_add_u32 m0, s94, 25600
    s_add_u32 s7, s93, 57344
    buffer_load_dwordx4 v60, s[8:11], s7 offen lds
    s_add_u32 m0, s94, 32768
    s_add_u32 s7, s93, 65536
    buffer_load_dwordx4 v60, s[8:11], s7 offen lds
    s_add_u32 m0, s94, 33792
    s_add_u32 s7, s93, 73728
    buffer_load_dwordx4 v60, s[8:11], s7 offen lds
    s_add_u32 m0, s94, 40960
    s_add_u32 s7, s93, 81920
    buffer_load_dwordx4 v60, s[8:11], s7 offen lds
    s_add_u32 m0, s94, 41984
    s_add_u32 s7, s93, 90112
    buffer_load_dwordx4 v60, s[8:11], s7 offen lds
    s_add_u32 m0, s94, 49152
    s_add_u32 s7, s93, 98304
    buffer_load_dwordx4 v60, s[8:11], s7 offen lds
    s_add_u32 m0, s94, 50176
    s_add_u32 s7, s93, 106496
    buffer_load_dwordx4 v60, s[8:11], s7 offen lds
    s_add_u32 m0, s94, 57344
    s_add_u32 s7, s93, 114688
    buffer_load_dwordx4 v60, s[8:11], s7 offen lds
    s_add_u32 m0, s94, 58368
    s_add_u32 s7, s93, 122880
    buffer_load_dwordx4 v60, s[8:11], s7 offen lds
    s_add_u32 m0, s94, 65536
    s_add_u32 s7, s93, 131072
    buffer_load_dwordx4 v60, s[8:11], s7 offen lds
    s_add_u32 m0, s94, 66560
    s_add_u32 s7, s93, 139264
    buffer_load_dwordx4 v60, s[8:11], s7 offen lds
    s_add_u32 m0, s94, 73728
    s_add_u32 s7, s93, 147456
    buffer_load_dwordx4 v60, s[8:11], s7 offen lds
    s_add_u32 m0, s94, 74752
    s_add_u32 s7, s93, 155648
    buffer_load_dwordx4 v60, s[8:11], s7 offen lds
    v_mov_b32 v13, 158304
NON_4:
    ds_read_b64 v[16:17], v13 offset:16
    s_waitcnt lgkmcnt(0)
    v_readfirstlane_b32 s86, v16
    v_readfirstlane_b32 s87, v17
    s_cmp_lg_u32 s86, 0
    s_cbranch_scc0 NON_4
    s_mov_b32 s73, 19939328
    s_mov_b32 s74, 0
L_AP:
    buffer_load_dwordx4 v[16:19], v2, s[64:67], s73 offen sc1
    buffer_load_dwordx4 v[20:23], v2, s[64:67], s73 offen offset:1024 sc1
    s_add_u32 s74, s74, 1
    s_waitcnt vmcnt(0)
    v_xor_b32 v16, s86, v16
    v_xor_b32 v17, s87, v17
    v_xor_b32 v18, s86, v18
    v_xor_b32 v19, s87, v19
    v_xor_b32 v20, s86, v20
    v_xor_b32 v21, s87, v21
    v_xor_b32 v22, s86, v22
    v_xor_b32 v23, s87, v23
    v_or3_b32 v16, v16, v17, v18
    v_or3_b32 v19, v19, v20, v21
    v_or3_b32 v16, v16, v22, v23
    v_or_b32 v16, v16, v19
    v_cmp_ne_u32 vcc, 0, v16
    s_cbranch_vccz L_AOK
    s_cmp_ge_u32 s74, 0x4000
    s_cbranch_scc1 L_AOK
    s_sleep 8
    s_branch L_AP
L_AOK:
    s_lshr_b32 s54, s3, 1
    s_and_b32 s55, s3, 1
    s_add_u32 s71, s70, s54
    s_mul_i32 s72, s54, 25856
    s_lshr_b32 s68, s70, 3
    s_lshl_b32 s68, s68, 9
    s_and_b32 s69, s70, 7
    s_lshl_b32 s69, s69, 1
    s_add_u32 s68, s68, s69
    s_lshl_b32 s69, s3, 19
    s_add_u32 s68, s68, s69
    s_add_u32 s68, s68, 20971520
    v_and_b32 v6, 31, v0
    v_lshrrev_b32 v7, 5, v0
    v_lshlrev_b32 v6, 4, v6
    v_lshl_add_u32 v6, v7, 15, v6
    buffer_load_dword v40, v6, s[64:67], s68 offen sc1
    s_add_u32 s68, s68, 65536
    buffer_load_dword v41, v6, s[64:67], s68 offen sc1
    s_add_u32 s68, s68, 65536
    buffer_load_dword v42, v6, s[64:67], s68 offen sc1
    s_add_u32 s68, s68, 65536
    buffer_load_dword v43, v6, s[64:67], s68 offen sc1
    s_add_u32 s68, s68, 65536
    buffer_load_dword v44, v6, s[64:67], s68 offen sc1
    s_add_u32 s68, s68, 65536
    buffer_load_dword v45, v6, s[64:67], s68 offen sc1
    s_add_u32 s68, s68, 65536
    buffer_load_dword v46, v6, s[64:67], s68 offen sc1
    s_add_u32 s68, s68, 65536
    buffer_load_dword v47, v6, s[64:67], s68 offen sc1
    s_lshl_b32 s73, s71, 1
    v_mov_b32 v3, s73
    global_load_ushort v56, v3, s[32:33]
    v_mov_b32 v8, 0
    v_mov_b32 v9, 0
    v_mov_b32 v10, 0
    v_mov_b32 v11, 0
    v_mov_b32 v12, 155840
    ds_write_b128 v12, v[8:11]
    v_bfe_u32 v4, v0, 2, 2
    v_and_b32 v5, 3, v0
    v_mul_u32_u24 v4, 4160, v4
    v_lshl_add_u32 v4, v5, 4, v4
    v_bfe_u32 v5, v0, 4, 1
    v_mul_u32_u24 v5, 25856, v5
    v_add_u32 v13, v4, v5
    s_mul_i32 s73, s55, 4576
    s_add_u32 s73, s73, s72
    v_add_u32 v14, s73, v2
    s_lshl_b32 s73, s3, 10
    v_add_u32 v4, s73, v2
    v_lshlrev_b32 v5, 1, v0
    v_add_u32 v5, s73, v5
    s_cmp_eq_u32 s3, 3
    s_cselect_b32 s73, -1, 0
    s_waitcnt lgkmcnt(0)
    s_barrier
    s_setprio 3
    s_mov_b32 exec_lo, s73
    s_mov_b32 exec_hi, 0
    ds_write_b128 v13, v[8:11] offset:4096
    s_mov_b32 exec_lo, 0x1fffffff
    ds_write_b128 v14, v[8:11] offset:16704
    s_mov_b64 exec, -1
    ds_write_b32 v4, v200 offset:4
    ds_write_b32 v4, v201 offset:8
    ds_write_b32 v4, v202 offset:12
    ds_write_b32 v4, v203 offset:16
    ds_write_b64 v4, v[200:201] offset:4168
    ds_write_b64 v4, v[202:203] offset:4176
    ds_write_b32 v4, v200 offset:8332
    ds_write_b32 v4, v201 offset:8336
    ds_write_b32 v4, v202 offset:8340
    ds_write_b32 v4, v203 offset:8344
    ds_write_b128 v4, v[200:203] offset:12496
    ds_write_b32 v4, v204 offset:25860
    ds_write_b32 v4, v205 offset:25864
    ds_write_b32 v4, v206 offset:25868
    ds_write_b32 v4, v207 offset:25872
    ds_write_b64 v4, v[204:205] offset:30024
    ds_write_b64 v4, v[206:207] offset:30032
    ds_write_b32 v4, v204 offset:34188
    ds_write_b32 v4, v205 offset:34192
    ds_write_b32 v4, v206 offset:34196
    ds_write_b32 v4, v207 offset:34200
    ds_write_b128 v4, v[204:207] offset:38352
    v_mov_b32 v16, 1
    s_waitcnt lgkmcnt(0)
    s_mov_b64 exec, 1
    ds_add_u32 v12, v16 offset:0
    s_mov_b64 exec, -1
SPIN_5:
    ds_read_b32 v17, v12 offset:0
    s_waitcnt lgkmcnt(0)
    v_readfirstlane_b32 s73, v17
    s_cmp_ge_u32 s73, 4
    s_cbranch_scc0 SPIN_5
    s_waitcnt vmcnt(8)
    ds_write_b16 v5, v40 offset:21728
    ds_write_b16 v5, v40 offset:17154
    ds_write_b16_d16_hi v5, v40 offset:47584
    ds_write_b16_d16_hi v5, v40 offset:43010
    s_waitcnt vmcnt(7)
    ds_write_b16 v5, v41 offset:21856
    ds_write_b16 v5, v41 offset:17282
    ds_write_b16_d16_hi v5, v41 offset:47712
    ds_write_b16_d16_hi v5, v41 offset:43138
    s_waitcnt vmcnt(6)
    ds_write_b16 v5, v42 offset:21984
    ds_write_b16 v5, v42 offset:17410
    ds_write_b16_d16_hi v5, v42 offset:47840
    ds_write_b16_d16_hi v5, v42 offset:43266
    s_waitcnt vmcnt(5)
    ds_write_b16 v5, v43 offset:22112
    ds_write_b16 v5, v43 offset:17538
    ds_write_b16_d16_hi v5, v43 offset:47968
    ds_write_b16_d16_hi v5, v43 offset:43394
    s_waitcnt vmcnt(4)
    ds_write_b16 v5, v44 offset:22240
    ds_write_b16 v5, v44 offset:17666
    ds_write_b16_d16_hi v5, v44 offset:48096
    ds_write_b16_d16_hi v5, v44 offset:43522
    s_waitcnt vmcnt(3)
    ds_write_b16 v5, v45 offset:22368
    ds_write_b16 v5, v45 offset:17794
    ds_write_b16_d16_hi v5, v45 offset:48224
    ds_write_b16_d16_hi v5, v45 offset:43650
    s_waitcnt vmcnt(2)
    ds_write_b16 v5, v46 offset:22496
    ds_write_b16 v5, v46 offset:17922
    ds_write_b16_d16_hi v5, v46 offset:48352
    ds_write_b16_d16_hi v5, v46 offset:43778
    s_waitcnt vmcnt(1)
    ds_write_b16 v5, v47 offset:22624
    ds_write_b16 v5, v47 offset:18050
    ds_write_b16_d16_hi v5, v47 offset:48480
    ds_write_b16_d16_hi v5, v47 offset:43906
    v_and_b32 v6, 15, v0
    v_lshrrev_b32 v7, 4, v0
    v_and_b32 v8, 3, v6
    v_mul_u32_u24 v8, 4160, v8
    v_lshrrev_b32 v9, 2, v6
    v_sub_u32 v9, v7, v9
    v_lshl_add_u32 v8, v9, 4, v8
    s_add_u32 s73, s72, 512
    v_add_u32 v8, s73, v8
    v_lshrrev_b32 v13, 3, v6
    v_and_b32 v14, 7, v6
    v_mul_u32_u24 v9, 4576, v13
    v_lshl_add_u32 v9, v14, 6, v9
    v_lshl_add_u32 v9, v7, 4, v9
    s_add_u32 s73, s72, 17152
    v_add_u32 v9, s73, v9
    v_mov_b32 v10, 1
    s_waitcnt lgkmcnt(0)
    s_mov_b64 exec, 1
    ds_add_u32 v12, v10 offset:0
    s_mov_b64 exec, -1
    v_mov_b32 v16, 0
    v_mov_b32 v17, 0
    v_mov_b32 v18, 0
    v_mov_b32 v19, 0
    v_mov_b32 v20, 0
    v_mov_b32 v21, 0
    v_mov_b32 v22, 0
    v_mov_b32 v23, 0
    v_mov_b32 v24, 0
    v_mov_b32 v25, 0
    v_mov_b32 v26, 0
    v_mov_b32 v27, 0
    v_mov_b32 v28, 0
    v_mov_b32 v29, 0
    v_mov_b32 v30, 0
    v_mov_b32 v31, 0
SPIN_6:
    ds_read_b32 v10, v12 offset:0
    s_waitcnt lgkmcnt(0)
    v_readfirstlane_b32 s73, v10
    s_cmp_ge_u32 s73, 8
    s_cbranch_scc0 SPIN_6
    s_cmp_eq_u32 s55, 0
    s_cbranch_scc0 K_CONV_Y
    ds_read_b128 v[64:67], v8 offset:3584
    ds_read_b128 v[96:99], v9 offset:0
    ds_read_b128 v[68:71], v8 offset:3072
    ds_read_b128 v[100:103], v9 offset:512
    ds_read_b128 v[72:75], v8 offset:2560
    ds_read_b128 v[104:107], v9 offset:1024
    ds_read_b128 v[76:79], v8 offset:2048
    ds_read_b128 v[108:111], v9 offset:1536
    ds_read_b128 v[80:83], v8 offset:1536
    ds_read_b128 v[112:115], v9 offset:2048
    ds_read_b128 v[84:87], v8 offset:1024
    ds_read_b128 v[116:119], v9 offset:2560
    ds_read_b128 v[88:91], v8 offset:512
    ds_read_b128 v[120:123], v9 offset:3072
    ds_read_b128 v[92:95], v8 offset:0
    ds_read_b128 v[124:127], v9 offset:3584
    v_subrev_u32 v8, 64, v8
    v_subrev_u32 v9, 64, v9
    s_mov_b32 s73, 0
K_CLOOP_X:
    s_waitcnt lgkmcnt(0)
    v_mfma_f32_16x16x32_bf16 v[28:31], v[64:67], v[96:99], v[28:31]
    ds_read_b128 v[128:131], v8 offset:3584
    v_mfma_f32_16x16x32_bf16 v[20:23], v[72:75], v[104:107], v[20:23]
    ds_read_b128 v[160:163], v9 offset:0
    v_mfma_f32_16x16x32_bf16 v[24:27], v[68:71], v[104:107], v[24:27]
    ds_read_b128 v[132:135], v8 offset:3072
    ds_read_b128 v[164:167], v9 offset:512
    v_mfma_f32_16x16x32_bf16 v[24:27], v[72:75], v[100:103], v[24:27]
    ds_read_b128 v[136:139], v8 offset:2560
    v_mfma_f32_16x16x32_bf16 v[20:23], v[68:71], v[108:111], v[20:23]
    ds_read_b128 v[168:171], v9 offset:1024
    v_mfma_f32_16x16x32_bf16 v[20:23], v[76:79], v[100:103], v[20:23]
    ds_read_b128 v[140:143], v8 offset:2048
    ds_read_b128 v[172:175], v9 offset:1536
    v_mfma_f32_16x16x32_bf16 v[24:27], v[64:67], v[108:111], v[24:27]
    ds_read_b128 v[144:147], v8 offset:1536
    v_mfma_f32_16x16x32_bf16 v[24:27], v[76:79], v[96:99], v[24:27]
    ds_read_b128 v[176:179], v9 offset:2048
    v_mfma_f32_16x16x32_bf16 v[16:19], v[76:79], v[112:115], v[16:19]
    ds_read_b128 v[148:151], v8 offset:1024
    ds_read_b128 v[180:183], v9 offset:2560
    v_mfma_f32_16x16x32_bf16 v[16:19], v[80:83], v[108:111], v[16:19]
    ds_read_b128 v[152:155], v8 offset:512
    v_mfma_f32_16x16x32_bf16 v[20:23], v[64:67], v[112:115], v[20:23]
    ds_read_b128 v[184:187], v9 offset:3072
    v_mfma_f32_16x16x32_bf16 v[20:23], v[80:83], v[96:99], v[20:23]
    ds_read_b128 v[156:159], v8 offset:0
    ds_read_b128 v[188:191], v9 offset:3584
    v_mfma_f32_16x16x32_bf16 v[16:19], v[72:75], v[116:119], v[16:19]
    v_mfma_f32_16x16x32_bf16 v[16:19], v[84:87], v[104:107], v[16:19]
    v_mfma_f32_16x16x32_bf16 v[16:19], v[68:71], v[120:123], v[16:19]
    v_mfma_f32_16x16x32_bf16 v[16:19], v[88:91], v[100:103], v[16:19]
    v_mfma_f32_16x16x32_bf16 v[16:19], v[64:67], v[124:127], v[16:19]
    v_mfma_f32_16x16x32_bf16 v[16:19], v[92:95], v[96:99], v[16:19]
    v_subrev_u32 v8, 64, v8
    v_subrev_u32 v9, 64, v9
    s_add_u32 s73, s73, 1
    s_cmp_eq_u32 s73, 4
    s_waitcnt lgkmcnt(0)
    s_cbranch_scc1 K_CLOOP_X_T
    v_mfma_f32_16x16x32_bf16 v[28:31], v[128:131], v[160:163], v[28:31]
    ds_read_b128 v[64:67], v8 offset:3584
    v_mfma_f32_16x16x32_bf16 v[20:23], v[136:139], v[168:171], v[20:23]
    ds_read_b128 v[96:99], v9 offset:0
    v_mfma_f32_16x16x32_bf16 v[24:27], v[132:135], v[168:171], v[24:27]
    ds_read_b128 v[68:71], v8 offset:3072
    ds_read_b128 v[100:103], v9 offset:512
    v_mfma_f32_16x16x32_bf16 v[24:27], v[136:139], v[164:167], v[24:27]
    ds_read_b128 v[72:75], v8 offset:2560
    v_mfma_f32_16x16x32_bf16 v[20:23], v[132:135], v[172:175], v[20:23]
    ds_read_b128 v[104:107], v9 offset:1024
    v_mfma_f32_16x16x32_bf16 v[20:23], v[140:143], v[164:167], v[20:23]
    ds_read_b128 v[76:79], v8 offset:2048
    ds_read_b128 v[108:111], v9 offset:1536
    v_mfma_f32_16x16x32_bf16 v[24:27], v[128:131], v[172:175], v[24:27]
    ds_read_b128 v[80:83], v8 offset:1536
    v_mfma_f32_16x16x32_bf16 v[24:27], v[140:143], v[160:163], v[24:27]
    ds_read_b128 v[112:115], v9 offset:2048
    v_mfma_f32_16x16x32_bf16 v[16:19], v[140:143], v[176:179], v[16:19]
    ds_read_b128 v[84:87], v8 offset:1024
    ds_read_b128 v[116:119], v9 offset:2560
    v_mfma_f32_16x16x32_bf16 v[16:19], v[144:147], v[172:175], v[16:19]
    ds_read_b128 v[88:91], v8 offset:512
    v_mfma_f32_16x16x32_bf16 v[20:23], v[128:131], v[176:179], v[20:23]
    ds_read_b128 v[120:123], v9 offset:3072
    v_mfma_f32_16x16x32_bf16 v[20:23], v[144:147], v[160:163], v[20:23]
    ds_read_b128 v[92:95], v8 offset:0
    ds_read_b128 v[124:127], v9 offset:3584
    v_mfma_f32_16x16x32_bf16 v[16:19], v[136:139], v[180:183], v[16:19]
    v_mfma_f32_16x16x32_bf16 v[16:19], v[148:151], v[168:171], v[16:19]
    v_mfma_f32_16x16x32_bf16 v[16:19], v[132:135], v[184:187], v[16:19]
    v_mfma_f32_16x16x32_bf16 v[16:19], v[152:155], v[164:167], v[16:19]
    v_mfma_f32_16x16x32_bf16 v[16:19], v[128:131], v[188:191], v[16:19]
    v_mfma_f32_16x16x32_bf16 v[16:19], v[156:159], v[160:163], v[16:19]
    v_subrev_u32 v8, 64, v8
    v_subrev_u32 v9, 64, v9
    s_branch K_CLOOP_X
K_CLOOP_X_T:
    v_mfma_f32_16x16x32_bf16 v[28:31], v[128:131], v[160:163], v[28:31]
    v_mfma_f32_16x16x32_bf16 v[20:23], v[136:139], v[168:171], v[20:23]
    v_mfma_f32_16x16x32_bf16 v[24:27], v[132:135], v[168:171], v[24:27]
    v_mfma_f32_16x16x32_bf16 v[24:27], v[136:139], v[164:167], v[24:27]
    v_mfma_f32_16x16x32_bf16 v[20:23], v[132:135], v[172:175], v[20:23]
    v_mfma_f32_16x16x32_bf16 v[20:23], v[140:143], v[164:167], v[20:23]
    v_mfma_f32_16x16x32_bf16 v[24:27], v[128:131], v[172:175], v[24:27]
    v_mfma_f32_16x16x32_bf16 v[24:27], v[140:143], v[160:163], v[24:27]
    v_mfma_f32_16x16x32_bf16 v[16:19], v[140:143], v[176:179], v[16:19]
    v_mfma_f32_16x16x32_bf16 v[16:19], v[144:147], v[172:175], v[16:19]
    v_mfma_f32_16x16x32_bf16 v[20:23], v[128:131], v[176:179], v[20:23]
    v_mfma_f32_16x16x32_bf16 v[20:23], v[144:147], v[160:163], v[20:23]
    v_mfma_f32_16x16x32_bf16 v[16:19], v[136:139], v[180:183], v[16:19]
    v_mfma_f32_16x16x32_bf16 v[16:19], v[148:151], v[168:171], v[16:19]
    v_mfma_f32_16x16x32_bf16 v[16:19], v[132:135], v[184:187], v[16:19]
    v_mfma_f32_16x16x32_bf16 v[16:19], v[152:155], v[164:167], v[16:19]
    v_mfma_f32_16x16x32_bf16 v[16:19], v[128:131], v[188:191], v[16:19]
    v_mfma_f32_16x16x32_bf16 v[16:19], v[156:159], v[160:163], v[16:19]
    v_xor_b32 v10, 1, v13
    v_mul_u32_u24 v10, 1536, v10
    s_mov_b32 s98, 2048
    s_mov_b32 s99, 0
    s_branch K_CONV_EPI
K_CONV_Y:
    ds_read_b128 v[64:67], v8 offset:3584
    ds_read_b128 v[96:99], v9 offset:0
    ds_read_b128 v[68:71], v8 offset:3072
    ds_read_b128 v[100:103], v9 offset:512
    ds_read_b128 v[72:75], v8 offset:2560
    ds_read_b128 v[104:107], v9 offset:1024
    ds_read_b128 v[76:79], v8 offset:2048
    ds_read_b128 v[108:111], v9 offset:1536
    ds_read_b128 v[80:83], v8 offset:1536
    ds_read_b128 v[112:115], v9 offset:2048
    ds_read_b128 v[84:87], v8 offset:1024
    ds_read_b128 v[116:119], v9 offset:2560
    ds_read_b128 v[88:91], v8 offset:512
    ds_read_b128 v[120:123], v9 offset:3072
    v_subrev_u32 v8, 64, v8
    v_subrev_u32 v9, 64, v9
    s_mov_b32 s73, 0
K_CLOOP_Y:
    s_waitcnt lgkmcnt(0)
    v_mfma_f32_16x16x32_bf16 v[24:27], v[68:71], v[100:103], v[24:27]
    ds_read_b128 v[128:131], v8 offset:3584
    v_mfma_f32_16x16x32_bf16 v[28:31], v[64:67], v[100:103], v[28:31]
    ds_read_b128 v[160:163], v9 offset:0
    v_mfma_f32_16x16x32_bf16 v[28:31], v[68:71], v[96:99], v[28:31]
    ds_read_b128 v[132:135], v8 offset:3072
    ds_read_b128 v[164:167], v9 offset:512
    v_mfma_f32_16x16x32_bf16 v[24:27], v[64:67], v[104:107], v[24:27]
    ds_read_b128 v[136:139], v8 offset:2560
    v_mfma_f32_16x16x32_bf16 v[24:27], v[72:75], v[96:99], v[24:27]
    ds_read_b128 v[168:171], v9 offset:1024
    v_mfma_f32_16x16x32_bf16 v[16:19], v[76:79], v[108:111], v[16:19]
    ds_read_b128 v[140:143], v8 offset:2048
    ds_read_b128 v[172:175], v9 offset:1536
    v_mfma_f32_16x16x32_bf16 v[20:23], v[72:75], v[108:111], v[20:23]
    ds_read_b128 v[144:147], v8 offset:1536
    v_mfma_f32_16x16x32_bf16 v[20:23], v[76:79], v[104:107], v[20:23]
    ds_read_b128 v[176:179], v9 offset:2048
    v_mfma_f32_16x16x32_bf16 v[16:19], v[72:75], v[112:115], v[16:19]
    ds_read_b128 v[148:151], v8 offset:1024
    ds_read_b128 v[180:183], v9 offset:2560
    v_mfma_f32_16x16x32_bf16 v[16:19], v[80:83], v[104:107], v[16:19]
    ds_read_b128 v[152:155], v8 offset:512
    v_mfma_f32_16x16x32_bf16 v[20:23], v[68:71], v[112:115], v[20:23]
    ds_read_b128 v[184:187], v9 offset:3072
    v_mfma_f32_16x16x32_bf16 v[20:23], v[80:83], v[100:103], v[20:23]
    v_mfma_f32_16x16x32_bf16 v[16:19], v[68:71], v[116:119], v[16:19]
    v_mfma_f32_16x16x32_bf16 v[16:19], v[84:87], v[100:103], v[16:19]
    v_mfma_f32_16x16x32_bf16 v[20:23], v[64:67], v[116:119], v[20:23]
    v_mfma_f32_16x16x32_bf16 v[20:23], v[84:87], v[96:99], v[20:23]
    v_mfma_f32_16x16x32_bf16 v[16:19], v[64:67], v[120:123], v[16:19]
    v_mfma_f32_16x16x32_bf16 v[16:19], v[88:91], v[96:99], v[16:19]
    v_subrev_u32 v8, 64, v8
    v_subrev_u32 v9, 64, v9
    s_add_u32 s73, s73, 1
    s_cmp_eq_u32 s73, 4
    s_waitcnt lgkmcnt(0)
    s_cbranch_scc1 K_CLOOP_Y_T
    v_mfma_f32_16x16x32_bf16 v[24:27], v[132:135], v[164:167], v[24:27]
    ds_read_b128 v[64:67], v8 offset:3584
    v_mfma_f32_16x16x32_bf16 v[28:31], v[128:131], v[164:167], v[28:31]
    ds_read_b128 v[96:99], v9 offset:0
    v_mfma_f32_16x16x32_bf16 v[28:31], v[132:135], v[160:163], v[28:31]
    ds_read_b128 v[68:71], v8 offset:3072
    ds_read_b128 v[100:103], v9 offset:512
    v_mfma_f32_16x16x32_bf16 v[24:27], v[128:131], v[168:171], v[24:27]
    ds_read_b128 v[72:75], v8 offset:2560
    v_mfma_f32_16x16x32_bf16 v[24:27], v[136:139], v[160:163], v[24:27]
    ds_read_b128 v[104:107], v9 offset:1024
    v_mfma_f32_16x16x32_bf16 v[16:19], v[140:143], v[172:175], v[16:19]
    ds_read_b128 v[76:79], v8 offset:2048
    ds_read_b128 v[108:111], v9 offset:1536
    v_mfma_f32_16x16x32_bf16 v[20:23], v[136:139], v[172:175], v[20:23]
    ds_read_b128 v[80:83], v8 offset:1536
    v_mfma_f32_16x16x32_bf16 v[20:23], v[140:143], v[168:171], v[20:23]
    ds_read_b128 v[112:115], v9 offset:2048
    v_mfma_f32_16x16x32_bf16 v[16:19], v[136:139], v[176:179], v[16:19]
    ds_read_b128 v[84:87], v8 offset:1024
    ds_read_b128 v[116:119], v9 offset:2560
    v_mfma_f32_16x16x32_bf16 v[16:19], v[144:147], v[168:171], v[16:19]
    ds_read_b128 v[88:91], v8 offset:512
    v_mfma_f32_16x16x32_bf16 v[20:23], v[132:135], v[176:179], v[20:23]
    ds_read_b128 v[120:123], v9 offset:3072
    v_mfma_f32_16x16x32_bf16 v[20:23], v[144:147], v[164:167], v[20:23]
    v_mfma_f32_16x16x32_bf16 v[16:19], v[132:135], v[180:183], v[16:19]
    v_mfma_f32_16x16x32_bf16 v[16:19], v[148:151], v[164:167], v[16:19]
    v_mfma_f32_16x16x32_bf16 v[20:23], v[128:131], v[180:183], v[20:23]
    v_mfma_f32_16x16x32_bf16 v[20:23], v[148:151], v[160:163], v[20:23]
    v_mfma_f32_16x16x32_bf16 v[16:19], v[128:131], v[184:187], v[16:19]
    v_mfma_f32_16x16x32_bf16 v[16:19], v[152:155], v[160:163], v[16:19]
    v_subrev_u32 v8, 64, v8
    v_subrev_u32 v9, 64, v9
    s_branch K_CLOOP_Y
K_CLOOP_Y_T:
    v_mfma_f32_16x16x32_bf16 v[24:27], v[132:135], v[164:167], v[24:27]
    v_mfma_f32_16x16x32_bf16 v[28:31], v[128:131], v[164:167], v[28:31]
    v_mfma_f32_16x16x32_bf16 v[28:31], v[132:135], v[160:163], v[28:31]
    v_mfma_f32_16x16x32_bf16 v[24:27], v[128:131], v[168:171], v[24:27]
    v_mfma_f32_16x16x32_bf16 v[24:27], v[136:139], v[160:163], v[24:27]
    v_mfma_f32_16x16x32_bf16 v[16:19], v[140:143], v[172:175], v[16:19]
    v_mfma_f32_16x16x32_bf16 v[20:23], v[136:139], v[172:175], v[20:23]
    v_mfma_f32_16x16x32_bf16 v[20:23], v[140:143], v[168:171], v[20:23]
    v_mfma_f32_16x16x32_bf16 v[16:19], v[136:139], v[176:179], v[16:19]
    v_mfma_f32_16x16x32_bf16 v[16:19], v[144:147], v[168:171], v[16:19]
    v_mfma_f32_16x16x32_bf16 v[20:23], v[132:135], v[176:179], v[20:23]
    v_mfma_f32_16x16x32_bf16 v[20:23], v[144:147], v[164:167], v[20:23]
    v_mfma_f32_16x16x32_bf16 v[16:19], v[132:135], v[180:183], v[16:19]
    v_mfma_f32_16x16x32_bf16 v[16:19], v[148:151], v[164:167], v[16:19]
    v_mfma_f32_16x16x32_bf16 v[20:23], v[128:131], v[180:183], v[20:23]
    v_mfma_f32_16x16x32_bf16 v[20:23], v[148:151], v[160:163], v[20:23]
    v_mfma_f32_16x16x32_bf16 v[16:19], v[128:131], v[184:187], v[16:19]
    v_mfma_f32_16x16x32_bf16 v[16:19], v[152:155], v[160:163], v[16:19]
    v_xor_b32 v10, 1, v13
    v_mul_u32_u24 v10, 512, v10
    s_mov_b32 s98, 2560
    s_mov_b32 s99, 512
K_CONV_EPI:
    v_lshlrev_b32 v11, 6, v14
    v_lshl_add_u32 v11, v7, 4, v11
    v_add_u32 v11, v11, v10
    s_add_u32 s73, s72, 21728
    s_add_u32 s75, s73, s98
    s_add_u32 s76, s73, s99
    v_add_u32 v32, s75, v11
    v_add_u32 v33, s76, v11
    ds_read_b128 v[36:39], v32
    ds_read_b128 v[40:43], v33
    v_cmp_eq_u32 vcc, 1, v13
    v_mov_b32 v34, 0x05040100
    v_mov_b32 v35, 0x01000504
    v_mov_b32 v44, 0x07060302
    v_mov_b32 v45, 0x03020706
    v_cndmask_b32 v34, v34, v35, vcc
    v_cndmask_b32 v35, v44, v45, vcc
    s_waitcnt vmcnt(0)
    v_lshlrev_b32 v57, 16, v56
    s_lshl_b32 s73, s71, 12
    s_add_u32 s73, s73, 16777216
    s_add_u32 s75, s73, s98
    s_add_u32 s76, s73, s99
    s_mov_b32 s78, 0x00003f80
    s_mov_b32 s79, 0x3f800000
    v_mov_b32 v58, 1
    v_cvt_pk_bf16_f32 v64, v16, v17
    v_cvt_pk_bf16_f32 v65, v18, v19
    v_cvt_pk_bf16_f32 v66, v20, v21
    v_cvt_pk_bf16_f32 v67, v22, v23
    v_cndmask_b32 v68, v64, v66, vcc
    v_cndmask_b32 v69, v65, v67, vcc
    v_cndmask_b32 v70, v66, v64, vcc
    v_cndmask_b32 v71, v67, v65, vcc
    v_cvt_pk_bf16_f32 v96, v24, v25
    v_cvt_pk_bf16_f32 v97, v26, v27
    v_cvt_pk_bf16_f32 v98, v28, v29
    v_cvt_pk_bf16_f32 v99, v30, v31
    v_cndmask_b32 v100, v96, v98, vcc
    v_cndmask_b32 v101, v97, v99, vcc
    v_cndmask_b32 v102, v98, v96, vcc
    v_cndmask_b32 v103, v99, v97, vcc
    v_mov_b32_dpp v64, v70 row_ror:8 row_mask:0xf bank_mask:0xf
    v_mov_b32_dpp v65, v71 row_ror:8 row_mask:0xf bank_mask:0xf
    v_mov_b32_dpp v96, v102 row_ror:8 row_mask:0xf bank_mask:0xf
    v_mov_b32_dpp v97, v103 row_ror:8 row_mask:0xf bank_mask:0xf
    s_waitcnt lgkmcnt(0)
    v_perm_b32 v72, v64, v68, v34
    v_perm_b32 v73, v64, v68, v35
    v_perm_b32 v74, v65, v69, v34
    v_perm_b32 v75, v65, v69, v35
    v_dot2_f32_bf16 v80, v36, v56, 0
    v_dot2_f32_bf16 v81, v36, v57, 0
    v_dot2_f32_bf16 v82, v37, v56, 0
    v_dot2_f32_bf16 v83, v37, v57, 0
    v_dot2_f32_bf16 v84, v38, v56, 0
    v_dot2_f32_bf16 v85, v38, v57, 0
    v_dot2_f32_bf16 v86, v39, v56, 0
    v_dot2_f32_bf16 v87, v39, v57, 0
    v_cvt_pk_bf16_f32 v80, 0, v80
    v_cvt_pk_bf16_f32 v81, 0, v81
    v_cvt_pk_bf16_f32 v82, 0, v82
    v_cvt_pk_bf16_f32 v83, 0, v83
    v_cvt_pk_bf16_f32 v84, 0, v84
    v_cvt_pk_bf16_f32 v85, 0, v85
    v_cvt_pk_bf16_f32 v86, 0, v86
    v_cvt_pk_bf16_f32 v87, 0, v87
    v_dot2_f32_bf16 v80, v72, s78, v80
    v_dot2_f32_bf16 v81, v72, s79, v81
    v_dot2_f32_bf16 v82, v73, s78, v82
    v_dot2_f32_bf16 v83, v73, s79, v83
    v_dot2_f32_bf16 v84, v74, s78, v84
    v_dot2_f32_bf16 v85, v74, s79, v85
    v_dot2_f32_bf16 v86, v75, s78, v86
    v_dot2_f32_bf16 v87, v75, s79, v87
    s_nop 0
    v_cvt_pk_bf16_f32 v76, v80, v81
    v_cvt_pk_bf16_f32 v77, v82, v83
    v_cvt_pk_bf16_f32 v78, v84, v85
    v_cvt_pk_bf16_f32 v79, v86, v87
    v_min_u32 v76, -2, v76
    v_min_u32 v77, -2, v77
    v_min_u32 v78, -2, v78
    v_min_u32 v79, -2, v79
    buffer_store_dwordx4 v[76:79], v11, s[64:67], s75 offen sc1
    v_perm_b32 v104, v96, v100, v34
    v_perm_b32 v105, v96, v100, v35
    v_perm_b32 v106, v97, v101, v34
    v_perm_b32 v107, v97, v101, v35
    v_dot2_f32_bf16 v112, v40, v56, 0
    v_dot2_f32_bf16 v113, v40, v57, 0
    v_dot2_f32_bf16 v114, v41, v56, 0
    v_dot2_f32_bf16 v115, v41, v57, 0
    v_dot2_f32_bf16 v116, v42, v56, 0
    v_dot2_f32_bf16 v117, v42, v57, 0
    v_dot2_f32_bf16 v118, v43, v56, 0
    v_dot2_f32_bf16 v119, v43, v57, 0
    v_cvt_pk_bf16_f32 v112, 0, v112
    v_cvt_pk_bf16_f32 v113, 0, v113
    v_cvt_pk_bf16_f32 v114, 0, v114
    v_cvt_pk_bf16_f32 v115, 0, v115
    v_cvt_pk_bf16_f32 v116, 0, v116
    v_cvt_pk_bf16_f32 v117, 0, v117
    v_cvt_pk_bf16_f32 v118, 0, v118
    v_cvt_pk_bf16_f32 v119, 0, v119
    v_dot2_f32_bf16 v112, v104, s78, v112
    v_dot2_f32_bf16 v113, v104, s79, v113
    v_dot2_f32_bf16 v114, v105, s78, v114
    v_dot2_f32_bf16 v115, v105, s79, v115
    v_dot2_f32_bf16 v116, v106, s78, v116
    v_dot2_f32_bf16 v117, v106, s79, v117
    v_dot2_f32_bf16 v118, v107, s78, v118
    v_dot2_f32_bf16 v119, v107, s79, v119
    s_nop 0
    v_cvt_pk_bf16_f32 v108, v112, v113
    v_cvt_pk_bf16_f32 v109, v114, v115
    v_cvt_pk_bf16_f32 v110, v116, v117
    v_cvt_pk_bf16_f32 v111, v118, v119
    v_min_u32 v108, -2, v108
    v_min_u32 v109, -2, v109
    v_min_u32 v110, -2, v110
    v_min_u32 v111, -2, v111
    buffer_store_dwordx4 v[108:111], v11, s[64:67], s76 offen sc1
    s_mov_b32 s56, s16
    s_and_b32 s57, s17, 0xffff
    s_mov_b32 s58, 0x200000
    s_mov_b32 s59, 0x20000
    v_lshlrev_b32 v5, 10, v6
    v_lshl_add_u32 v5, v7, 4, v5
    s_lshl_b32 s68, s51, 16
    s_lshl_b32 s69, s3, 14
    s_add_u32 s68, s68, s69
    s_lshl_b32 s69, s52, 7
    s_add_u32 s76, s68, s69
    buffer_load_dwordx4 v[80:83], v5, s[56:59], s76 offen
    buffer_load_dwordx4 v[84:87], v5, s[56:59], s76 offen offset:64
    s_mov_b32 s74, 0
    v_lshrrev_b32 v16, 3, v0
    v_and_b32 v17, 7, v0
    v_lshlrev_b32 v18, 12, v16
    v_lshl_add_u32 v18, v17, 4, v18
    s_lshl_b32 s68, s52, 18
    s_lshl_b32 s69, s3, 16
    s_add_u32 s68, s68, s69
    s_lshl_b32 s69, s51, 7
    s_add_u32 s68, s68, s69
    s_add_u32 s68, s68, 16777216
    s_add_u32 s69, s68, 32768
    v_mul_u32_u24 v19, 144, v16
    v_lshl_add_u32 v19, v17, 4, v19
    s_mul_i32 s73, s3, 2304
    s_add_u32 s73, s73, 51712
    v_add_u32 v19, s73, v19
    v_lshrrev_b32 v20, 2, v6
    v_lshl_add_u32 v20, v7, 3, v20
    v_mul_u32_u24 v20, 144, v20
    v_and_b32 v21, 3, v6
    v_lshl_add_u32 v20, v21, 3, v20
    s_lshl_b32 s73, s3, 5
    s_add_u32 s73, s73, 51712
    v_add_u32 v20, s73, v20
    v_mul_u32_u24 v21, 136, v6
    v_lshl_add_u32 v21, v7, 4, v21
    s_mul_i32 s73, s3, 2176
    s_add_u32 s73, s73, 60928
    v_add_u32 v21, s73, v21
    s_setprio 0
K_POLL:
    s_sleep 16
    buffer_load_dwordx4 v[88:91], v18, s[64:67], s68 offen sc1
    buffer_load_dwordx4 v[92:95], v18, s[64:67], s69 offen sc1
    s_add_u32 s74, s74, 1
    s_waitcnt vmcnt(0)
    v_max3_u32 v10, v88, v89, v90
    v_max3_u32 v16, v91, v92, v93
    v_max3_u32 v10, v10, v94, v95
    v_max_u32 v10, v10, v16
    v_cmp_eq_u32 vcc, -1, v10
    s_cmp_ge_u32 s74, 0x2000
    s_cbranch_scc1 K_POLLED
    s_cbranch_vccnz K_POLL
K_POLLED:
    ds_write_b128 v19, v[88:91]
    ds_write_b128 v19, v[92:95] offset:1152
    s_waitcnt lgkmcnt(0)
    s_mov_b64 exec, 1
    ds_add_u32 v12, v58 offset:8
    s_mov_b64 exec, -1
    v_lshlrev_b32 v96, 16, v80
    v_and_b32 v97, 0xffff0000, v80
    v_lshlrev_b32 v98, 16, v81
    v_and_b32 v99, 0xffff0000, v81
    v_lshlrev_b32 v100, 16, v82
    v_and_b32 v101, 0xffff0000, v82
    v_lshlrev_b32 v102, 16, v83
    v_and_b32 v103, 0xffff0000, v83
    v_lshlrev_b32 v104, 16, v84
    v_and_b32 v105, 0xffff0000, v84
    v_lshlrev_b32 v106, 16, v85
    v_and_b32 v107, 0xffff0000, v85
    v_lshlrev_b32 v108, 16, v86
    v_and_b32 v109, 0xffff0000, v86
    v_lshlrev_b32 v110, 16, v87
    v_and_b32 v111, 0xffff0000, v87
SPIN_7:
    ds_read_b32 v10, v12 offset:8
    s_waitcnt lgkmcnt(0)
    v_readfirstlane_b32 s73, v10
    s_cmp_ge_u32 s73, 4
    s_cbranch_scc0 SPIN_7
    ds_read_b64_tr_b16 v[88:89], v20 offset:0
    ds_read_b64_tr_b16 v[90:91], v20 offset:576
    ds_read_b64_tr_b16 v[92:93], v20 offset:4608
    ds_read_b64_tr_b16 v[94:95], v20 offset:5184
    s_waitcnt lgkmcnt(0)
    v_dot2_f32_bf16 v96, v88, s78, v96
    v_dot2_f32_bf16 v97, v88, s79, v97
    v_dot2_f32_bf16 v98, v89, s78, v98
    v_dot2_f32_bf16 v99, v89, s79, v99
    v_dot2_f32_bf16 v100, v90, s78, v100
    v_dot2_f32_bf16 v101, v90, s79, v101
    v_dot2_f32_bf16 v102, v91, s78, v102
    v_dot2_f32_bf16 v103, v91, s79, v103
    v_dot2_f32_bf16 v104, v92, s78, v104
    v_dot2_f32_bf16 v105, v92, s79, v105
    v_dot2_f32_bf16 v106, v93, s78, v106
    v_dot2_f32_bf16 v107, v93, s79, v107
    v_dot2_f32_bf16 v108, v94, s78, v108
    v_dot2_f32_bf16 v109, v94, s79, v109
    v_dot2_f32_bf16 v110, v95, s78, v110
    v_dot2_f32_bf16 v111, v95, s79, v111
    s_nop 0
    v_cvt_pk_bf16_f32 v112, v96, v97
    v_cvt_pk_bf16_f32 v113, v98, v99
    v_cvt_pk_bf16_f32 v114, v100, v101
    v_cvt_pk_bf16_f32 v115, v102, v103
    ds_write_b64 v21, v[112:113] offset:0
    ds_write_b64 v21, v[114:115] offset:8
    v_cvt_pk_bf16_f32 v116, v104, v105
    v_cvt_pk_bf16_f32 v117, v106, v107
    v_cvt_pk_bf16_f32 v118, v108, v109
    v_cvt_pk_bf16_f32 v119, v110, v111
    ds_write_b64 v21, v[116:117] offset:64
    ds_write_b64 v21, v[118:119] offset:72
    s_waitcnt lgkmcnt(0)
    s_barrier
    s_endpgm
K_MM:
    s_setprio 3
    s_cmp_lg_u32 s3, 0
    s_cbranch_scc1 M_NOLN
    v_and_b32 v12, 7, v0
    v_lshrrev_b32 v13, 3, v0
    s_lshl_b32 s4, s48, 4
    s_add_u32 s4, s4, s49
    s_lshl_b32 s5, s4, 13
    v_lshlrev_b32 v4, 10, v12
    v_lshl_add_u32 v4, v13, 4, v4
    v_add_u32 v4, s5, v4
    s_waitcnt lgkmcnt(0)
    s_mov_b32 s56, s16
    s_and_b32 s57, s17, 0xffff
    s_mov_b32 s58, 0x200000
    s_mov_b32 s59, 0x20000
    buffer_load_dwordx4 v[32:35], v4, s[56:59], 0 offen offset:0
    buffer_load_dwordx4 v[36:39], v4, s[56:59], 0 offen offset:128
    buffer_load_dwordx4 v[40:43], v4, s[56:59], 0 offen offset:256
    buffer_load_dwordx4 v[44:47], v4, s[56:59], 0 offen offset:384
    buffer_load_dwordx4 v[48:51], v4, s[56:59], 0 offen offset:512
    buffer_load_dwordx4 v[52:55], v4, s[56:59], 0 offen offset:640
    buffer_load_dwordx4 v[56:59], v4, s[56:59], 0 offen offset:768
    buffer_load_dwordx4 v[60:63], v4, s[56:59], 0 offen offset:896
    s_barrier
    s_mov_b32 s64, s46
    s_and_b32 s65, s47, 0xffff
    s_mov_b32 s66, 0x10000000
    s_mov_b32 s67, 0x20000
    s_mov_b32 s78, 0x00003f80
    s_mov_b32 s79, 0x3f800000
    s_mov_b32 s80, 0x3f803f80
    v_lshlrev_b32 v5, 12, v13
    v_lshl_add_u32 v5, v12, 4, v5
    s_lshl_b32 s6, s52, 18
    s_lshl_b32 s7, s51, 7
    s_add_u32 s6, s6, s7
    s_add_u32 s6, s6, 16777216
    v_mov_b32 v64, -1
    v_mov_b32 v65, -1
    v_mov_b32 v66, -1
    v_mov_b32 v67, -1
    buffer_store_dwordx4 v[64:67], v5, s[64:67], s6 offen sc1
    s_add_u32 s6, s6, 32768
    buffer_store_dwordx4 v[64:67], v5, s[64:67], s6 offen sc1
    s_add_u32 s6, s6, 32768
    buffer_store_dwordx4 v[64:67], v5, s[64:67], s6 offen sc1
    s_add_u32 s6, s6, 32768
    buffer_store_dwordx4 v[64:67], v5, s[64:67], s6 offen sc1
    s_add_u32 s6, s6, 32768
    buffer_store_dwordx4 v[64:67], v5, s[64:67], s6 offen sc1
    s_add_u32 s6, s6, 32768
    buffer_store_dwordx4 v[64:67], v5, s[64:67], s6 offen sc1
    s_add_u32 s6, s6, 32768
    buffer_store_dwordx4 v[64:67], v5, s[64:67], s6 offen sc1
    s_add_u32 s6, s6, 32768
    buffer_store_dwordx4 v[64:67], v5, s[64:67], s6 offen sc1
    v_lshlrev_b32 v3, 9, v13
    v_lshl_add_u32 v3, v12, 4, v3
    s_lshr_b32 s6, s4, 2
    s_lshl_b32 s6, s6, 15
    s_and_b32 s7, s4, 3
    s_lshl_b32 s7, s7, 7
    s_add_u32 s6, s6, s7
    s_add_u32 s6, s6, 20971520
M_LNC:
    v_mov_b32 v6, 0
    v_mov_b32 v7, 0
    v_mov_b32 v8, 0
    v_mov_b32 v9, 0
    s_waitcnt vmcnt(15)
    v_dot2c_f32_bf16 v8, s80, v32
    v_dot2c_f32_bf16 v6, s80, v33
    v_dot2c_f32_bf16 v8, s80, v34
    v_dot2c_f32_bf16 v6, s80, v35
    s_waitcnt vmcnt(14)
    v_dot2c_f32_bf16 v8, s80, v36
    v_dot2c_f32_bf16 v6, s80, v37
    v_dot2c_f32_bf16 v8, s80, v38
    v_dot2c_f32_bf16 v6, s80, v39
    s_waitcnt vmcnt(13)
    v_dot2c_f32_bf16 v8, s80, v40
    v_dot2c_f32_bf16 v6, s80, v41
    v_dot2c_f32_bf16 v8, s80, v42
    v_dot2c_f32_bf16 v6, s80, v43
    s_waitcnt vmcnt(12)
    v_dot2c_f32_bf16 v8, s80, v44
    v_dot2c_f32_bf16 v6, s80, v45
    v_dot2c_f32_bf16 v8, s80, v46
    v_dot2c_f32_bf16 v6, s80, v47
    s_waitcnt vmcnt(11)
    v_dot2c_f32_bf16 v8, s80, v48
    v_dot2c_f32_bf16 v6, s80, v49
    v_dot2c_f32_bf16 v8, s80, v50
    v_dot2c_f32_bf16 v6, s80, v51
    s_waitcnt vmcnt(10)
    v_dot2c_f32_bf16 v8, s80, v52
    v_dot2c_f32_bf16 v6, s80, v53
    v_dot2c_f32_bf16 v8, s80, v54
    v_dot2c_f32_bf16 v6, s80, v55
    s_waitcnt vmcnt(9)
    v_dot2c_f32_bf16 v8, s80, v56
    v_dot2c_f32_bf16 v6, s80, v57
    v_dot2c_f32_bf16 v8, s80, v58
    v_dot2c_f32_bf16 v6, s80, v59
    s_waitcnt vmcnt(8)
    v_dot2c_f32_bf16 v8, s80, v60
    v_dot2c_f32_bf16 v6, s80, v61
    v_dot2c_f32_bf16 v8, s80, v62
    v_dot2c_f32_bf16 v6, s80, v63
    s_nop 2
    v_add_f32 v6, v6, v8
    s_nop 1
    v_add_f32_dpp v6, v6, v6 row_ror:8 row_mask:0xf bank_mask:0xf
    v_mov_b32 v8, v6
    s_nop 1
    v_permlane16_swap_b32 v6, v8
    v_add_f32 v6, v6, v8
    v_mov_b32 v8, v6
    s_nop 1
    v_permlane32_swap_b32 v6, v8
    v_add_f32 v6, v6, v8
    v_mul_f32 v6, 0xbb000000, v6
    v_cvt_pk_bf16_f32 v14, 0, v6
    v_sub_f32 v6, v6, v14
    v_dot2_f32_bf16 v128, v32, s78, v14
    v_dot2_f32_bf16 v129, v32, s79, v14
    v_dot2_f32_bf16 v130, v33, s78, v14
    v_dot2_f32_bf16 v131, v33, s79, v14
    v_dot2_f32_bf16 v132, v34, s78, v14
    v_dot2_f32_bf16 v133, v34, s79, v14
    v_dot2_f32_bf16 v134, v35, s78, v14
    v_dot2_f32_bf16 v135, v35, s79, v14
    v_dot2_f32_bf16 v136, v36, s78, v14
    v_dot2_f32_bf16 v137, v36, s79, v14
    v_dot2_f32_bf16 v138, v37, s78, v14
    v_dot2_f32_bf16 v139, v37, s79, v14
    v_dot2_f32_bf16 v140, v38, s78, v14
    v_dot2_f32_bf16 v141, v38, s79, v14
    v_dot2_f32_bf16 v142, v39, s78, v14
    v_dot2_f32_bf16 v143, v39, s79, v14
    v_fmac_f32 v9, v128, v128
    v_fmac_f32 v7, v129, v129
    v_fmac_f32 v9, v130, v130
    v_fmac_f32 v7, v131, v131
    v_fmac_f32 v9, v132, v132
    v_fmac_f32 v7, v133, v133
    v_fmac_f32 v9, v134, v134
    v_fmac_f32 v7, v135, v135
    v_dot2_f32_bf16 v144, v40, s78, v14
    v_dot2_f32_bf16 v145, v40, s79, v14
    v_dot2_f32_bf16 v146, v41, s78, v14
    v_dot2_f32_bf16 v147, v41, s79, v14
    v_dot2_f32_bf16 v148, v42, s78, v14
    v_dot2_f32_bf16 v149, v42, s79, v14
    v_dot2_f32_bf16 v150, v43, s78, v14
    v_dot2_f32_bf16 v151, v43, s79, v14
    v_fmac_f32 v9, v136, v136
    v_fmac_f32 v7, v137, v137
    v_fmac_f32 v9, v138, v138
    v_fmac_f32 v7, v139, v139
    v_fmac_f32 v9, v140, v140
    v_fmac_f32 v7, v141, v141
    v_fmac_f32 v9, v142, v142
    v_fmac_f32 v7, v143, v143
    v_dot2_f32_bf16 v152, v44, s78, v14
    v_dot2_f32_bf16 v153, v44, s79, v14
    v_dot2_f32_bf16 v154, v45, s78, v14
    v_dot2_f32_bf16 v155, v45, s79, v14
    v_dot2_f32_bf16 v156, v46, s78, v14
    v_dot2_f32_bf16 v157, v46, s79, v14
    v_dot2_f32_bf16 v158, v47, s78, v14
    v_dot2_f32_bf16 v159, v47, s79, v14
    v_fmac_f32 v9, v144, v144
    v_fmac_f32 v7, v145, v145
    v_fmac_f32 v9, v146, v146
    v_fmac_f32 v7, v147, v147
    v_fmac_f32 v9, v148, v148
    v_fmac_f32 v7, v149, v149
    v_fmac_f32 v9, v150, v150
    v_fmac_f32 v7, v151, v151
    v_dot2_f32_bf16 v160, v48, s78, v14
    v_dot2_f32_bf16 v161, v48, s79, v14
    v_dot2_f32_bf16 v162, v49, s78, v14
    v_dot2_f32_bf16 v163, v49, s79, v14
    v_dot2_f32_bf16 v164, v50, s78, v14
    v_dot2_f32_bf16 v165, v50, s79, v14
    v_dot2_f32_bf16 v166, v51, s78, v14
    v_dot2_f32_bf16 v167, v51, s79, v14
    v_fmac_f32 v9, v152, v152
    v_fmac_f32 v7, v153, v153
    v_fmac_f32 v9, v154, v154
    v_fmac_f32 v7, v155, v155
    v_fmac_f32 v9, v156, v156
    v_fmac_f32 v7, v157, v157
    v_fmac_f32 v9, v158, v158
    v_fmac_f32 v7, v159, v159
    v_dot2_f32_bf16 v168, v52, s78, v14
    v_dot2_f32_bf16 v169, v52, s79, v14
    v_dot2_f32_bf16 v170, v53, s78, v14
    v_dot2_f32_bf16 v171, v53, s79, v14
    v_dot2_f32_bf16 v172, v54, s78, v14
    v_dot2_f32_bf16 v173, v54, s79, v14
    v_dot2_f32_bf16 v174, v55, s78, v14
    v_dot2_f32_bf16 v175, v55, s79, v14
    v_fmac_f32 v9, v160, v160
    v_fmac_f32 v7, v161, v161
    v_fmac_f32 v9, v162, v162
    v_fmac_f32 v7, v163, v163
    v_fmac_f32 v9, v164, v164
    v_fmac_f32 v7, v165, v165
    v_fmac_f32 v9, v166, v166
    v_fmac_f32 v7, v167, v167
    v_dot2_f32_bf16 v176, v56, s78, v14
    v_dot2_f32_bf16 v177, v56, s79, v14
    v_dot2_f32_bf16 v178, v57, s78, v14
    v_dot2_f32_bf16 v179, v57, s79, v14
    v_dot2_f32_bf16 v180, v58, s78, v14
    v_dot2_f32_bf16 v181, v58, s79, v14
    v_dot2_f32_bf16 v182, v59, s78, v14
    v_dot2_f32_bf16 v183, v59, s79, v14
    v_fmac_f32 v9, v168, v168
    v_fmac_f32 v7, v169, v169
    v_fmac_f32 v9, v170, v170
    v_fmac_f32 v7, v171, v171
    v_fmac_f32 v9, v172, v172
    v_fmac_f32 v7, v173, v173
    v_fmac_f32 v9, v174, v174
    v_fmac_f32 v7, v175, v175
    v_dot2_f32_bf16 v184, v60, s78, v14
    v_dot2_f32_bf16 v185, v60, s79, v14
    v_dot2_f32_bf16 v186, v61, s78, v14
    v_dot2_f32_bf16 v187, v61, s79, v14
    v_dot2_f32_bf16 v188, v62, s78, v14
    v_dot2_f32_bf16 v189, v62, s79, v14
    v_dot2_f32_bf16 v190, v63, s78, v14
    v_dot2_f32_bf16 v191, v63, s79, v14
    v_fmac_f32 v9, v176, v176
    v_fmac_f32 v7, v177, v177
    v_fmac_f32 v9, v178, v178
    v_fmac_f32 v7, v179, v179
    v_fmac_f32 v9, v180, v180
    v_fmac_f32 v7, v181, v181
    v_fmac_f32 v9, v182, v182
    v_fmac_f32 v7, v183, v183
    s_nop 0
    v_fmac_f32 v9, v184, v184
    v_fmac_f32 v7, v185, v185
    v_fmac_f32 v9, v186, v186
    v_fmac_f32 v7, v187, v187
    v_fmac_f32 v9, v188, v188
    v_fmac_f32 v7, v189, v189
    v_fmac_f32 v9, v190, v190
    v_fmac_f32 v7, v191, v191
    v_add_f32 v7, v7, v9
    s_nop 1
    v_add_f32_dpp v7, v7, v7 row_ror:8 row_mask:0xf bank_mask:0xf
    v_mov_b32 v9, v7
    s_nop 1
    v_permlane16_swap_b32 v7, v9
    v_add_f32 v7, v7, v9
    v_mov_b32 v9, v7
    s_nop 1
    v_permlane32_swap_b32 v7, v9
    v_add_f32 v7, v7, v9
    v_mul_f32 v7, 0x3b000000, v7
    v_fma_f32 v7, -v6, v6, v7
    v_max_f32 v7, 0, v7
    v_cvt_pk_bf16_f32 v7, 0, v7
    v_add_f32 v7, 0x3727c5ac, v7
    v_cvt_pk_bf16_f32 v7, 0, v7
    v_sqrt_f32 v7, v7
    v_cvt_pk_bf16_f32 v128, 0, v128
    v_cvt_pk_bf16_f32 v129, 0, v129
    v_cvt_pk_bf16_f32 v130, 0, v130
    v_cvt_pk_bf16_f32 v131, 0, v131
    v_cvt_pk_bf16_f32 v132, 0, v132
    v_cvt_pk_bf16_f32 v133, 0, v133
    v_cvt_pk_bf16_f32 v134, 0, v134
    v_cvt_pk_bf16_f32 v135, 0, v135
    v_cvt_pk_bf16_f32 v7, 0, v7
    v_rcp_f32 v10, v7
    v_cvt_pk_bf16_f32 v136, 0, v136
    v_cvt_pk_bf16_f32 v137, 0, v137
    v_cvt_pk_bf16_f32 v138, 0, v138
    v_cvt_pk_bf16_f32 v139, 0, v139
    v_cvt_pk_bf16_f32 v140, 0, v140
    v_cvt_pk_bf16_f32 v141, 0, v141
    v_cvt_pk_bf16_f32 v142, 0, v142
    v_cvt_pk_bf16_f32 v143, 0, v143
    v_fma_f32 v11, -v7, v10, 1.0
    v_fma_f32 v10, v10, v11, v10
    v_pk_mul_f32 v[128:129], v[128:129], v[10:11] op_sel_hi:[1,0]
    v_pk_mul_f32 v[130:131], v[130:131], v[10:11] op_sel_hi:[1,0]
    v_pk_mul_f32 v[132:133], v[132:133], v[10:11] op_sel_hi:[1,0]
    v_pk_mul_f32 v[134:135], v[134:135], v[10:11] op_sel_hi:[1,0]
    v_cvt_pk_bf16_f32 v32, v128, v129
    v_cvt_pk_bf16_f32 v33, v130, v131
    v_cvt_pk_bf16_f32 v34, v132, v133
    v_cvt_pk_bf16_f32 v35, v134, v135
    buffer_store_dwordx4 v[32:35], v3, s[64:67], s6 offen sc1
    s_add_u32 s6, s6, 4096
    v_pk_mul_f32 v[136:137], v[136:137], v[10:11] op_sel_hi:[1,0]
    v_pk_mul_f32 v[138:139], v[138:139], v[10:11] op_sel_hi:[1,0]
    v_pk_mul_f32 v[140:141], v[140:141], v[10:11] op_sel_hi:[1,0]
    v_pk_mul_f32 v[142:143], v[142:143], v[10:11] op_sel_hi:[1,0]
    v_cvt_pk_bf16_f32 v36, v136, v137
    v_cvt_pk_bf16_f32 v37, v138, v139
    v_cvt_pk_bf16_f32 v38, v140, v141
    v_cvt_pk_bf16_f32 v39, v142, v143
    buffer_store_dwordx4 v[36:39], v3, s[64:67], s6 offen sc1
    s_add_u32 s6, s6, 4096
    v_cvt_pk_bf16_f32 v144, 0, v144
    v_cvt_pk_bf16_f32 v145, 0, v145
    v_cvt_pk_bf16_f32 v146, 0, v146
    v_cvt_pk_bf16_f32 v147, 0, v147
    v_cvt_pk_bf16_f32 v148, 0, v148
    v_cvt_pk_bf16_f32 v149, 0, v149
    v_cvt_pk_bf16_f32 v150, 0, v150
    v_cvt_pk_bf16_f32 v151, 0, v151
    v_pk_mul_f32 v[144:145], v[144:145], v[10:11] op_sel_hi:[1,0]
    v_pk_mul_f32 v[146:147], v[146:147], v[10:11] op_sel_hi:[1,0]
    v_pk_mul_f32 v[148:149], v[148:149], v[10:11] op_sel_hi:[1,0]
    v_pk_mul_f32 v[150:151], v[150:151], v[10:11] op_sel_hi:[1,0]
    v_cvt_pk_bf16_f32 v40, v144, v145
    v_cvt_pk_bf16_f32 v41, v146, v147
    v_cvt_pk_bf16_f32 v42, v148, v149
    v_cvt_pk_bf16_f32 v43, v150, v151
    buffer_store_dwordx4 v[40:43], v3, s[64:67], s6 offen sc1
    s_add_u32 s6, s6, 4096
    v_cvt_pk_bf16_f32 v152, 0, v152
    v_cvt_pk_bf16_f32 v153, 0, v153
    v_cvt_pk_bf16_f32 v154, 0, v154
    v_cvt_pk_bf16_f32 v155, 0, v155
    v_cvt_pk_bf16_f32 v156, 0, v156
    v_cvt_pk_bf16_f32 v157, 0, v157
    v_cvt_pk_bf16_f32 v158, 0, v158
    v_cvt_pk_bf16_f32 v159, 0, v159
    v_pk_mul_f32 v[152:153], v[152:153], v[10:11] op_sel_hi:[1,0]
    v_pk_mul_f32 v[154:155], v[154:155], v[10:11] op_sel_hi:[1,0]
    v_pk_mul_f32 v[156:157], v[156:157], v[10:11] op_sel_hi:[1,0]
    v_pk_mul_f32 v[158:159], v[158:159], v[10:11] op_sel_hi:[1,0]
    v_cvt_pk_bf16_f32 v44, v152, v153
    v_cvt_pk_bf16_f32 v45, v154, v155
    v_cvt_pk_bf16_f32 v46, v156, v157
    v_cvt_pk_bf16_f32 v47, v158, v159
    buffer_store_dwordx4 v[44:47], v3, s[64:67], s6 offen sc1
    s_add_u32 s6, s6, 4096
    v_cvt_pk_bf16_f32 v160, 0, v160
    v_cvt_pk_bf16_f32 v161, 0, v161
    v_cvt_pk_bf16_f32 v162, 0, v162
    v_cvt_pk_bf16_f32 v163, 0, v163
    v_cvt_pk_bf16_f32 v164, 0, v164
    v_cvt_pk_bf16_f32 v165, 0, v165
    v_cvt_pk_bf16_f32 v166, 0, v166
    v_cvt_pk_bf16_f32 v167, 0, v167
    v_pk_mul_f32 v[160:161], v[160:161], v[10:11] op_sel_hi:[1,0]
    v_pk_mul_f32 v[162:163], v[162:163], v[10:11] op_sel_hi:[1,0]
    v_pk_mul_f32 v[164:165], v[164:165], v[10:11] op_sel_hi:[1,0]
    v_pk_mul_f32 v[166:167], v[166:167], v[10:11] op_sel_hi:[1,0]
    v_cvt_pk_bf16_f32 v48, v160, v161
    v_cvt_pk_bf16_f32 v49, v162, v163
    v_cvt_pk_bf16_f32 v50, v164, v165
    v_cvt_pk_bf16_f32 v51, v166, v167
    buffer_store_dwordx4 v[48:51], v3, s[64:67], s6 offen sc1
    s_add_u32 s6, s6, 4096
    v_cvt_pk_bf16_f32 v168, 0, v168
    v_cvt_pk_bf16_f32 v169, 0, v169
    v_cvt_pk_bf16_f32 v170, 0, v170
    v_cvt_pk_bf16_f32 v171, 0, v171
    v_cvt_pk_bf16_f32 v172, 0, v172
    v_cvt_pk_bf16_f32 v173, 0, v173
    v_cvt_pk_bf16_f32 v174, 0, v174
    v_cvt_pk_bf16_f32 v175, 0, v175
    v_pk_mul_f32 v[168:169], v[168:169], v[10:11] op_sel_hi:[1,0]
    v_pk_mul_f32 v[170:171], v[170:171], v[10:11] op_sel_hi:[1,0]
    v_pk_mul_f32 v[172:173], v[172:173], v[10:11] op_sel_hi:[1,0]
    v_pk_mul_f32 v[174:175], v[174:175], v[10:11] op_sel_hi:[1,0]
    v_cvt_pk_bf16_f32 v52, v168, v169
    v_cvt_pk_bf16_f32 v53, v170, v171
    v_cvt_pk_bf16_f32 v54, v172, v173
    v_cvt_pk_bf16_f32 v55, v174, v175
    buffer_store_dwordx4 v[52:55], v3, s[64:67], s6 offen sc1
    s_add_u32 s6, s6, 4096
    v_cvt_pk_bf16_f32 v176, 0, v176
    v_cvt_pk_bf16_f32 v177, 0, v177
    v_cvt_pk_bf16_f32 v178, 0, v178
    v_cvt_pk_bf16_f32 v179, 0, v179
    v_cvt_pk_bf16_f32 v180, 0, v180
    v_cvt_pk_bf16_f32 v181, 0, v181
    v_cvt_pk_bf16_f32 v182, 0, v182
    v_cvt_pk_bf16_f32 v183, 0, v183
    v_pk_mul_f32 v[176:177], v[176:177], v[10:11] op_sel_hi:[1,0]
    v_pk_mul_f32 v[178:179], v[178:179], v[10:11] op_sel_hi:[1,0]
    v_pk_mul_f32 v[180:181], v[180:181], v[10:11] op_sel_hi:[1,0]
    v_pk_mul_f32 v[182:183], v[182:183], v[10:11] op_sel_hi:[1,0]
    v_cvt_pk_bf16_f32 v56, v176, v177
    v_cvt_pk_bf16_f32 v57, v178, v179
    v_cvt_pk_bf16_f32 v58, v180, v181
    v_cvt_pk_bf16_f32 v59, v182, v183
    buffer_store_dwordx4 v[56:59], v3, s[64:67], s6 offen sc1
    s_add_u32 s6, s6, 4096
    v_cvt_pk_bf16_f32 v184, 0, v184
    v_cvt_pk_bf16_f32 v185, 0, v185
    v_cvt_pk_bf16_f32 v186, 0, v186
    v_cvt_pk_bf16_f32 v187, 0, v187
    v_cvt_pk_bf16_f32 v188, 0, v188
    v_cvt_pk_bf16_f32 v189, 0, v189
    v_cvt_pk_bf16_f32 v190, 0, v190
    v_cvt_pk_bf16_f32 v191, 0, v191
    v_pk_mul_f32 v[184:185], v[184:185], v[10:11] op_sel_hi:[1,0]
    v_pk_mul_f32 v[186:187], v[186:187], v[10:11] op_sel_hi:[1,0]
    v_pk_mul_f32 v[188:189], v[188:189], v[10:11] op_sel_hi:[1,0]
    v_pk_mul_f32 v[190:191], v[190:191], v[10:11] op_sel_hi:[1,0]
    v_cvt_pk_bf16_f32 v60, v184, v185
    v_cvt_pk_bf16_f32 v61, v186, v187
    v_cvt_pk_bf16_f32 v62, v188, v189
    v_cvt_pk_bf16_f32 v63, v190, v191
    buffer_store_dwordx4 v[60:63], v3, s[64:67], s6 offen sc1
    v_mov_b32 v4, s4
    v_mov_b32 v5, 1
    v_mov_b32 v13, 158304
    ds_write_b32 v13, v5 offset:8
    s_lshl_b32 s6, s4, 3
    s_add_u32 s6, s6, 19939328
    v_mov_b32 v4, 0
NON_8:
    ds_read_b64 v[6:7], v13 offset:16
    s_waitcnt lgkmcnt(0)
    v_readfirstlane_b32 s86, v6
    v_readfirstlane_b32 s87, v7
    s_cmp_lg_u32 s86, 0
    s_cbranch_scc0 NON_8
    s_waitcnt vmcnt(0)
    s_mov_b64 exec, 1
    buffer_store_dwordx2 v[6:7], v4, s[64:67], s6 offen sc1
    s_mov_b64 exec, -1
    s_branch M_LND
M_NOLN:
    s_waitcnt lgkmcnt(0)
    s_barrier
    s_mov_b32 s64, s46
    s_and_b32 s65, s47, 0xffff
    s_mov_b32 s66, 0x10000000
    s_mov_b32 s67, 0x20000
    s_cmp_eq_u32 s3, 3
    s_cbranch_scc1 M_W3
    s_cmp_eq_u32 s3, 2
    s_cselect_b32 s60, s38, s36
    s_cselect_b32 s61, s39, s37
    s_cselect_b32 s81, 12320, 0
    s_and_b32 s61, s61, 0xffff
    s_mov_b32 s62, 1409024
    s_mov_b32 s63, 0x20000
    s_mul_i32 s68, s2, 5504
    v_min_u32 v20, 42, v0
    v_lshlrev_b32 v20, 7, v20
    buffer_load_dword v104, v20, s[60:63], s68 offen
    v_mul_u32_u24 v20, 43, v0
    v_lshrrev_b32 v20, 9, v20
    v_mul_u32_u24 v21, 12, v20
    v_sub_u32 v21, v0, v21
    v_mul_u32_u24 v14, 2752, v20
    v_lshl_add_u32 v14, v21, 4, v14
    s_lshl_b32 s69, s50, 5
    v_add_u32 v14, s69, v14
    v_mov_b32 v13, 158304
    s_cmp_eq_u32 s49, 15
    s_cbranch_scc1 M_NODMA
    s_mov_b32 s82, 0
    s_mov_b32 s83, 0
M_DL:
    s_cmp_lg_u32 s83, 2
    s_cbranch_scc1 M_DL0
SPIN_9:
    s_sleep 1
    ds_read_b32 v16, v13 offset:8
    s_waitcnt lgkmcnt(0)
    v_readfirstlane_b32 s10, v16
    s_cmp_ge_u32 s10, 1
    s_cbranch_scc0 SPIN_9
M_DL0:
    s_mov_b32 m0, s81
    s_mov_b32 exec_lo, -1
    s_mov_b32 exec_hi, 0x0fffffff
    buffer_load_dwordx4 v14, s[60:63], s82 offen lds
    s_add_u32 m0, m0, 960
    s_add_u32 s82, s82, 13760
    buffer_load_dwordx4 v14, s[60:63], s82 offen lds
    s_add_u32 m0, m0, 960
    s_add_u32 s82, s82, 13760
    buffer_load_dwordx4 v14, s[60:63], s82 offen lds
    s_add_u32 m0, m0, 960
    s_add_u32 s82, s82, 13760
    buffer_load_dwordx4 v14, s[60:63], s82 offen lds
    s_add_u32 m0, m0, 960
    s_add_u32 s82, s82, 13760
    buffer_load_dwordx4 v14, s[60:63], s82 offen lds
    s_add_u32 m0, m0, 960
    s_add_u32 s82, s82, 13760
    buffer_load_dwordx4 v14, s[60:63], s82 offen lds
    s_add_u32 m0, m0, 960
    s_add_u32 s82, s82, 13760
    buffer_load_dwordx4 v14, s[60:63], s82 offen lds
    s_add_u32 m0, m0, 960
    s_add_u32 s82, s82, 13760
    buffer_load_dwordx4 v14, s[60:63], s82 offen lds
    s_add_u32 m0, m0, 960
    s_add_u32 s82, s82, 13760
    buffer_load_dwordx4 v14, s[60:63], s82 offen lds
    s_add_u32 m0, m0, 960
    s_add_u32 s82, s82, 13760
    buffer_load_dwordx4 v14, s[60:63], s82 offen lds
    s_add_u32 m0, m0, 960
    s_add_u32 s82, s82, 13760
    buffer_load_dwordx4 v14, s[60:63], s82 offen lds
    s_add_u32 m0, m0, 960
    s_add_u32 s82, s82, 13760
    buffer_load_dwordx4 v14, s[60:63], s82 offen lds
    s_add_u32 m0, m0, 960
    s_add_u32 s82, s82, 13760
    s_mov_b32 exec_hi, 0xffff
    buffer_load_dwordx4 v14, s[60:63], s82 offen lds
    s_add_u32 m0, m0, 960
    s_add_u32 s82, s82, 11008
    s_mov_b64 exec, -1
    s_add_u32 s81, s81, 24640
    s_add_u32 s83, s83, 1
    s_cmp_lg_u32 s83, 9
    s_cbranch_scc1 M_DL2
SPIN_10:
    s_sleep 1
    ds_read_b32 v16, v13 offset:4
    s_waitcnt lgkmcnt(0)
    v_readfirstlane_b32 s10, v16
    s_cmp_ge_u32 s10, 1
    s_cbranch_scc0 SPIN_10
M_DL2:
    s_cmp_lt_u32 s83, 5
    s_cbranch_scc1 M_DL
    v_mov_b32 v16, 1
    s_waitcnt vmcnt(0)
    s_mov_b64 exec, 1
    ds_add_u32 v13, v16 offset:12
    s_mov_b64 exec, -1
    s_branch M_NODMA
M_W3:
    v_mov_b32 v12, 0
    v_mov_b32 v13, 158304
    s_cmp_lg_u32 s2, 0
    s_cbranch_scc1 M_NP
    s_memrealtime s[4:5]
    s_waitcnt lgkmcnt(0)
    s_or_b32 s4, s4, 1
    v_mov_b32 v16, s4
    v_mov_b32 v17, s5
    s_mov_b64 exec, 1
    global_store_dwordx2 v12, v[16:17], s[44:45] sc1
    s_mov_b64 exec, -1
    ds_write_b32 v13, v13 offset:24
    s_branch M_NOK
M_NP:
    s_mov_b32 s10, 0
    s_sleep 16
M_NPL:
    s_sleep 3
    global_load_dwordx2 v[16:17], v12, s[44:45] sc1
    ds_write_b32 v13, v13 offset:24
    s_add_u32 s10, s10, 1
    s_waitcnt vmcnt(0)
    v_readfirstlane_b32 s4, v16
    s_cmp_ge_u32 s10, 0x4000
    s_cbranch_scc1 M_NTO
    s_cmp_eq_u32 s4, 0
    s_cbranch_scc1 M_NPL
    s_branch M_NOK
M_NTO:
    v_or_b32 v16, 1, v16
M_NOK:
    ds_write_b64 v13, v[16:17] offset:16
    s_cmp_ge_u32 s2, 16
    s_cbranch_scc1 M_NOPF
    s_getpc_b64 s[88:89]
M_PC:
    s_sub_u32 s88, s88, M_PC - parallel_sum__ssm_conv_s4__swiglu_ffn__prompt_kernel
    s_subb_u32 s89, s89, 0
    s_lshl_b32 s90, s3, 10
    s_and_b32 s90, s90, 0
    v_lshlrev_b32 v20, 4, v0
    v_add_u32 v20, s90, v20
    s_mov_b32 s90, 0
M_PFL:
    v_min_u32 v21, (K_END - parallel_sum__ssm_conv_s4__swiglu_ffn__prompt_kernel) & 0xfffffff0, v20
    global_load_dwordx4 v[100:103], v21, s[88:89]
    v_add_u32 v20, 1024, v20
    s_add_u32 s90, s90, 1024
    s_cmp_lt_u32 s90, K_END - parallel_sum__ssm_conv_s4__swiglu_ffn__prompt_kernel
    s_cbranch_scc1 M_PFL
M_NOPF:
M_LND:
M_NODMA:
    v_mov_b32 v13, 158304
    s_lshl_b32 s5, s48, 7
    s_add_u32 s5, s5, 19939328
    v_and_b32 v12, 15, v0
    v_lshlrev_b32 v12, 3, v12
    s_mov_b32 s10, 0
NON_11:
    ds_read_b64 v[16:17], v13 offset:16
    s_waitcnt lgkmcnt(0)
    v_readfirstlane_b32 s86, v16
    v_readfirstlane_b32 s87, v17
    s_cmp_lg_u32 s86, 0
    s_cbranch_scc0 NON_11
    s_cmp_lg_u32 s3, 0
    s_cbranch_scc1 M_LWAIT
M_LP:
    buffer_load_dwordx2 v[16:17], v12, s[64:67], s5 offen sc1
    s_add_u32 s10, s10, 1
    s_waitcnt vmcnt(0)
    v_xor_b32 v16, s86, v16
    v_xor_b32 v17, s87, v17
    v_or_b32 v16, v16, v17
    v_cmp_ne_u32 vcc, 0, v16
    s_cbranch_vccz M_LOK
    s_cmp_ge_u32 s10, 0x4000
    s_cbranch_scc1 M_LOK
    s_sleep 2
    s_branch M_LP
M_LOK:
    v_mov_b32 v16, 1
    ds_write_b32 v13, v16 offset:4
    s_branch M_LGO
M_LWAIT:
SPIN_12:
    ds_read_b32 v16, v13 offset:4
    s_waitcnt lgkmcnt(0)
    v_readfirstlane_b32 s10, v16
    s_cmp_ge_u32 s10, 1
    s_cbranch_scc0 SPIN_12
M_LGO:
    s_lshl_b32 s4, s48, 2
    s_add_u32 s4, s4, s3
    s_lshl_b32 s5, s4, 15
    s_add_u32 s5, s5, 20971520
    s_cmp_eq_u32 s49, 15
    s_cbranch_scc1 M_15
    buffer_load_dwordx4 v[128:131], v2, s[64:67], s5 offen offset:0 sc1
    buffer_load_dwordx4 v[132:135], v2, s[64:67], s5 offen offset:1024 sc1
    buffer_load_dwordx4 v[136:139], v2, s[64:67], s5 offen offset:2048 sc1
    buffer_load_dwordx4 v[140:143], v2, s[64:67], s5 offen offset:3072 sc1
    s_add_u32 s5, s5, 4096
    buffer_load_dwordx4 v[144:147], v2, s[64:67], s5 offen offset:0 sc1
    buffer_load_dwordx4 v[148:151], v2, s[64:67], s5 offen offset:1024 sc1
    buffer_load_dwordx4 v[152:155], v2, s[64:67], s5 offen offset:2048 sc1
    buffer_load_dwordx4 v[156:159], v2, s[64:67], s5 offen offset:3072 sc1
    s_add_u32 s5, s5, 4096
    buffer_load_dwordx4 v[160:163], v2, s[64:67], s5 offen offset:0 sc1
    buffer_load_dwordx4 v[164:167], v2, s[64:67], s5 offen offset:1024 sc1
    buffer_load_dwordx4 v[168:171], v2, s[64:67], s5 offen offset:2048 sc1
    buffer_load_dwordx4 v[172:175], v2, s[64:67], s5 offen offset:3072 sc1
    v_and_b32 v3, 15, v0
    v_bfe_u32 v4, v0, 4, 1
    v_lshrrev_b32 v5, 5, v0
    v_lshrrev_b32 v6, 2, v3
    v_lshl_add_u32 v6, v5, 3, v6
    v_mul_u32_u24 v9, 192, v6
    v_mul_u32_u24 v6, 12320, v4
    v_add_u32 v9, v9, v6
    v_and_b32 v6, 3, v3
    v_lshl_add_u32 v9, v6, 3, v9
    s_mul_i32 s14, s4, 86
    s_add_u32 s14, s14, s50
    s_lshl_b32 s14, s14, 10
    s_add_u32 s14, s14, 0
    s_add_u32 s15, s14, 4096
    s_mov_b32 s12, 0xbfb8aa3b
    s_mov_b32 s13, 0xbfb8aa3b
    v_add_u32 v10, 24640, v9
    v_add_u32 v11, 49280, v9
    v_add_u32 v12, 73920, v9
    v_add_u32 v13, 98560, v9
    s_mov_b32 s8, s40
    s_and_b32 s9, s41, 0xffff
    s_mov_b32 s10, 0x158000
    s_mov_b32 s11, 0x20000
    s_mul_i32 s92, s3, 22
    s_cmp_eq_u32 s3, 3
    s_cselect_b32 s92, 65, s92
    v_lshrrev_b32 v6, 3, v0
    v_and_b32 v7, 7, v0
    v_lshrrev_b32 v5, 2, v0
    v_and_b32 v5, 4, v5
    v_xor_b32 v7, v7, v5
    v_lshlrev_b32 v5, 10, v6
    v_lshl_add_u32 v5, v7, 4, v5
    s_lshl_b32 s93, s92, 14
    s_lshl_b32 s94, s52, 7
    s_add_u32 s93, s93, s94
    s_lshl_b32 s94, s3, 11
    s_add_u32 s94, s94, 73920
    v_mov_b32 v3, 158304
SPIN_13:
    ds_read_b32 v4, v3 offset:12
    s_waitcnt lgkmcnt(0)
    v_readfirstlane_b32 s95, v4
    s_cmp_ge_u32 s95, 2
    s_cbranch_scc0 SPIN_13
    s_setprio 2
    ds_read_b64_tr_b16 v[208:209], v9 offset:0
    ds_read_b64_tr_b16 v[210:211], v9 offset:768
    ds_read_b64_tr_b16 v[212:213], v9 offset:32
    ds_read_b64_tr_b16 v[214:215], v9 offset:800
    ds_read_b64_tr_b16 v[216:217], v9 offset:64
    ds_read_b64_tr_b16 v[218:219], v9 offset:832
    ds_read_b64_tr_b16 v[220:221], v9 offset:96
    ds_read_b64_tr_b16 v[222:223], v9 offset:864
    ds_read_b64_tr_b16 v[224:225], v9 offset:128
    ds_read_b64_tr_b16 v[226:227], v9 offset:896
    ds_read_b64_tr_b16 v[228:229], v9 offset:160
    ds_read_b64_tr_b16 v[230:231], v9 offset:928
    ds_read_b64_tr_b16 v[232:233], v9 offset:3072
    ds_read_b64_tr_b16 v[234:235], v9 offset:3840
    s_waitcnt lgkmcnt(12) vmcnt(11)
    v_mfma_f32_32x32x16_bf16 v[16:31], v[208:211], v[128:131], 0
    ds_read_b64_tr_b16 v[236:237], v9 offset:3104
    ds_read_b64_tr_b16 v[238:239], v9 offset:3872
    s_waitcnt lgkmcnt(12)
    v_mfma_f32_32x32x16_bf16 v[32:47], v[212:215], v[128:131], 0
    ds_read_b64_tr_b16 v[208:209], v9 offset:3136
    ds_read_b64_tr_b16 v[210:211], v9 offset:3904
    s_waitcnt lgkmcnt(12)
    v_mfma_f32_32x32x16_bf16 v[48:63], v[216:219], v[128:131], 0
    ds_read_b64_tr_b16 v[212:213], v9 offset:3168
    ds_read_b64_tr_b16 v[214:215], v9 offset:3936
    s_add_u32 s5, s5, 4096
    buffer_load_dwordx4 v[176:179], v2, s[64:67], s5 offen offset:0 sc1
    s_waitcnt lgkmcnt(12)
    v_mfma_f32_32x32x16_bf16 v[64:79], v[220:223], v[128:131], 0
    ds_read_b64_tr_b16 v[216:217], v9 offset:3200
    ds_read_b64_tr_b16 v[218:219], v9 offset:3968
    s_waitcnt lgkmcnt(12)
    v_mfma_f32_32x32x16_bf16 v[80:95], v[224:227], v[128:131], 0
    ds_read_b64_tr_b16 v[220:221], v9 offset:3232
    ds_read_b64_tr_b16 v[222:223], v9 offset:4000
    s_waitcnt lgkmcnt(12)
    v_mfma_f32_32x32x16_bf16 v[96:111], v[228:231], v[128:131], 0
    ds_read_b64_tr_b16 v[224:225], v9 offset:6144
    ds_read_b64_tr_b16 v[226:227], v9 offset:6912
    buffer_load_dwordx4 v[180:183], v2, s[64:67], s5 offen offset:1024 sc1
    s_waitcnt lgkmcnt(12) vmcnt(12)
    v_mfma_f32_32x32x16_bf16 v[16:31], v[232:235], v[132:135], v[16:31]
    ds_read_b64_tr_b16 v[228:229], v9 offset:6176
    ds_read_b64_tr_b16 v[230:231], v9 offset:6944
    s_waitcnt lgkmcnt(12)
    v_mfma_f32_32x32x16_bf16 v[32:47], v[236:239], v[132:135], v[32:47]
    ds_read_b64_tr_b16 v[232:233], v9 offset:6208
    ds_read_b64_tr_b16 v[234:235], v9 offset:6976
    s_waitcnt lgkmcnt(12)
    v_mfma_f32_32x32x16_bf16 v[48:63], v[208:211], v[132:135], v[48:63]
    ds_read_b64_tr_b16 v[236:237], v9 offset:6240
    ds_read_b64_tr_b16 v[238:239], v9 offset:7008
    buffer_load_dwordx4 v[184:187], v2, s[64:67], s5 offen offset:2048 sc1
    s_waitcnt lgkmcnt(12)
    v_mfma_f32_32x32x16_bf16 v[64:79], v[212:215], v[132:135], v[64:79]
    ds_read_b64_tr_b16 v[208:209], v9 offset:6272
    ds_read_b64_tr_b16 v[210:211], v9 offset:7040
    s_waitcnt lgkmcnt(12)
    v_mfma_f32_32x32x16_bf16 v[80:95], v[216:219], v[132:135], v[80:95]
    ds_read_b64_tr_b16 v[212:213], v9 offset:6304
    ds_read_b64_tr_b16 v[214:215], v9 offset:7072
    s_waitcnt lgkmcnt(12)
    v_mfma_f32_32x32x16_bf16 v[96:111], v[220:223], v[132:135], v[96:111]
    ds_read_b64_tr_b16 v[216:217], v9 offset:9216
    ds_read_b64_tr_b16 v[218:219], v9 offset:9984
    buffer_load_dwordx4 v[188:191], v2, s[64:67], s5 offen offset:3072 sc1
    s_waitcnt lgkmcnt(12) vmcnt(13)
    v_mfma_f32_32x32x16_bf16 v[16:31], v[224:227], v[136:139], v[16:31]
    ds_read_b64_tr_b16 v[220:221], v9 offset:9248
    ds_read_b64_tr_b16 v[222:223], v9 offset:10016
    s_waitcnt lgkmcnt(12)
    v_mfma_f32_32x32x16_bf16 v[32:47], v[228:231], v[136:139], v[32:47]
    ds_read_b64_tr_b16 v[224:225], v9 offset:9280
    ds_read_b64_tr_b16 v[226:227], v9 offset:10048
    s_waitcnt lgkmcnt(12)
    v_mfma_f32_32x32x16_bf16 v[48:63], v[232:235], v[136:139], v[48:63]
    ds_read_b64_tr_b16 v[228:229], v9 offset:9312
    ds_read_b64_tr_b16 v[230:231], v9 offset:10080
    s_add_u32 s5, s5, 4096
    buffer_load_dwordx4 v[192:195], v2, s[64:67], s5 offen offset:0 sc1
    s_waitcnt lgkmcnt(12)
    v_mfma_f32_32x32x16_bf16 v[64:79], v[236:239], v[136:139], v[64:79]
    ds_read_b64_tr_b16 v[232:233], v9 offset:9344
    ds_read_b64_tr_b16 v[234:235], v9 offset:10112
    s_waitcnt lgkmcnt(12)
    v_mfma_f32_32x32x16_bf16 v[80:95], v[208:211], v[136:139], v[80:95]
    ds_read_b64_tr_b16 v[236:237], v9 offset:9376
    ds_read_b64_tr_b16 v[238:239], v9 offset:10144
    s_waitcnt lgkmcnt(12)
    v_mfma_f32_32x32x16_bf16 v[96:111], v[212:215], v[136:139], v[96:111]
    ds_read_b64_tr_b16 v[208:209], v10 offset:0
    ds_read_b64_tr_b16 v[210:211], v10 offset:768
    buffer_load_dwordx4 v[196:199], v2, s[64:67], s5 offen offset:1024 sc1
    s_waitcnt lgkmcnt(12) vmcnt(14)
    v_mfma_f32_32x32x16_bf16 v[16:31], v[216:219], v[140:143], v[16:31]
    ds_read_b64_tr_b16 v[212:213], v10 offset:32
    ds_read_b64_tr_b16 v[214:215], v10 offset:800
    s_waitcnt lgkmcnt(12)
    v_mfma_f32_32x32x16_bf16 v[32:47], v[220:223], v[140:143], v[32:47]
    ds_read_b64_tr_b16 v[216:217], v10 offset:64
    ds_read_b64_tr_b16 v[218:219], v10 offset:832
    s_waitcnt lgkmcnt(12)
    v_mfma_f32_32x32x16_bf16 v[48:63], v[224:227], v[140:143], v[48:63]
    ds_read_b64_tr_b16 v[220:221], v10 offset:96
    ds_read_b64_tr_b16 v[222:223], v10 offset:864
    buffer_load_dwordx4 v[200:203], v2, s[64:67], s5 offen offset:2048 sc1
    s_waitcnt lgkmcnt(12)
    v_mfma_f32_32x32x16_bf16 v[64:79], v[228:231], v[140:143], v[64:79]
    ds_read_b64_tr_b16 v[224:225], v10 offset:128
    ds_read_b64_tr_b16 v[226:227], v10 offset:896
    s_waitcnt lgkmcnt(12)
    v_mfma_f32_32x32x16_bf16 v[80:95], v[232:235], v[140:143], v[80:95]
    ds_read_b64_tr_b16 v[228:229], v10 offset:160
    ds_read_b64_tr_b16 v[230:231], v10 offset:928
    s_waitcnt lgkmcnt(12)
    v_mfma_f32_32x32x16_bf16 v[96:111], v[236:239], v[140:143], v[96:111]
    ds_read_b64_tr_b16 v[232:233], v10 offset:3072
    ds_read_b64_tr_b16 v[234:235], v10 offset:3840
    buffer_load_dwordx4 v[204:207], v2, s[64:67], s5 offen offset:3072 sc1
    s_waitcnt lgkmcnt(12) vmcnt(15)
    v_mfma_f32_32x32x16_bf16 v[16:31], v[208:211], v[144:147], v[16:31]
    ds_read_b64_tr_b16 v[236:237], v10 offset:3104
    ds_read_b64_tr_b16 v[238:239], v10 offset:3872
    s_waitcnt lgkmcnt(12)
    v_mfma_f32_32x32x16_bf16 v[32:47], v[212:215], v[144:147], v[32:47]
    ds_read_b64_tr_b16 v[208:209], v10 offset:3136
    ds_read_b64_tr_b16 v[210:211], v10 offset:3904
    s_waitcnt lgkmcnt(12)
    v_mfma_f32_32x32x16_bf16 v[48:63], v[216:219], v[144:147], v[48:63]
    ds_read_b64_tr_b16 v[212:213], v10 offset:3168
    ds_read_b64_tr_b16 v[214:215], v10 offset:3936
    s_add_u32 s5, s5, 4096
    buffer_load_dwordx4 v[128:131], v2, s[64:67], s5 offen offset:0 sc1
    s_waitcnt lgkmcnt(12)
    v_mfma_f32_32x32x16_bf16 v[64:79], v[220:223], v[144:147], v[64:79]
    ds_read_b64_tr_b16 v[216:217], v10 offset:3200
    ds_read_b64_tr_b16 v[218:219], v10 offset:3968
    s_waitcnt lgkmcnt(12)
    v_mfma_f32_32x32x16_bf16 v[80:95], v[224:227], v[144:147], v[80:95]
    ds_read_b64_tr_b16 v[220:221], v10 offset:3232
    ds_read_b64_tr_b16 v[222:223], v10 offset:4000
    s_waitcnt lgkmcnt(12)
    v_mfma_f32_32x32x16_bf16 v[96:111], v[228:231], v[144:147], v[96:111]
    ds_read_b64_tr_b16 v[224:225], v10 offset:6144
    ds_read_b64_tr_b16 v[226:227], v10 offset:6912
    buffer_load_dwordx4 v[132:135], v2, s[64:67], s5 offen offset:1024 sc1
    s_waitcnt lgkmcnt(12) vmcnt(16)
    v_mfma_f32_32x32x16_bf16 v[16:31], v[232:235], v[148:151], v[16:31]
    ds_read_b64_tr_b16 v[228:229], v10 offset:6176
    ds_read_b64_tr_b16 v[230:231], v10 offset:6944
    s_waitcnt lgkmcnt(12)
    v_mfma_f32_32x32x16_bf16 v[32:47], v[236:239], v[148:151], v[32:47]
    ds_read_b64_tr_b16 v[232:233], v10 offset:6208
    ds_read_b64_tr_b16 v[234:235], v10 offset:6976
    s_waitcnt lgkmcnt(12)
    v_mfma_f32_32x32x16_bf16 v[48:63], v[208:211], v[148:151], v[48:63]
    ds_read_b64_tr_b16 v[236:237], v10 offset:6240
    ds_read_b64_tr_b16 v[238:239], v10 offset:7008
    buffer_load_dwordx4 v[136:139], v2, s[64:67], s5 offen offset:2048 sc1
    s_waitcnt lgkmcnt(12)
    v_mfma_f32_32x32x16_bf16 v[64:79], v[212:215], v[148:151], v[64:79]
    ds_read_b64_tr_b16 v[208:209], v10 offset:6272
    ds_read_b64_tr_b16 v[210:211], v10 offset:7040
    s_waitcnt lgkmcnt(12)
    v_mfma_f32_32x32x16_bf16 v[80:95], v[216:219], v[148:151], v[80:95]
    ds_read_b64_tr_b16 v[212:213], v10 offset:6304
    ds_read_b64_tr_b16 v[214:215], v10 offset:7072
    s_waitcnt lgkmcnt(12)
    v_mfma_f32_32x32x16_bf16 v[96:111], v[220:223], v[148:151], v[96:111]
    ds_read_b64_tr_b16 v[216:217], v10 offset:9216
    ds_read_b64_tr_b16 v[218:219], v10 offset:9984
    buffer_load_dwordx4 v[140:143], v2, s[64:67], s5 offen offset:3072 sc1
    s_waitcnt lgkmcnt(12) vmcnt(17)
    v_mfma_f32_32x32x16_bf16 v[16:31], v[224:227], v[152:155], v[16:31]
    ds_read_b64_tr_b16 v[220:221], v10 offset:9248
    ds_read_b64_tr_b16 v[222:223], v10 offset:10016
    s_waitcnt lgkmcnt(12)
    v_mfma_f32_32x32x16_bf16 v[32:47], v[228:231], v[152:155], v[32:47]
    ds_read_b64_tr_b16 v[224:225], v10 offset:9280
    ds_read_b64_tr_b16 v[226:227], v10 offset:10048
    s_waitcnt lgkmcnt(12)
    v_mfma_f32_32x32x16_bf16 v[48:63], v[232:235], v[152:155], v[48:63]
    ds_read_b64_tr_b16 v[228:229], v10 offset:9312
    ds_read_b64_tr_b16 v[230:231], v10 offset:10080
    s_add_u32 s5, s5, 4096
    buffer_load_dwordx4 v[144:147], v2, s[64:67], s5 offen offset:0 sc1
    s_waitcnt lgkmcnt(12)
    v_mfma_f32_32x32x16_bf16 v[64:79], v[236:239], v[152:155], v[64:79]
    ds_read_b64_tr_b16 v[232:233], v10 offset:9344
    ds_read_b64_tr_b16 v[234:235], v10 offset:10112
    s_waitcnt lgkmcnt(12)
    v_mfma_f32_32x32x16_bf16 v[80:95], v[208:211], v[152:155], v[80:95]
    ds_read_b64_tr_b16 v[236:237], v10 offset:9376
    ds_read_b64_tr_b16 v[238:239], v10 offset:10144
    s_waitcnt lgkmcnt(12)
    v_mfma_f32_32x32x16_bf16 v[96:111], v[212:215], v[152:155], v[96:111]
    s_barrier
    ds_read_b64_tr_b16 v[208:209], v11 offset:0
    ds_read_b64_tr_b16 v[210:211], v11 offset:768
    buffer_load_dwordx4 v[148:151], v2, s[64:67], s5 offen offset:1024 sc1
    s_waitcnt lgkmcnt(12) vmcnt(18)
    v_mfma_f32_32x32x16_bf16 v[16:31], v[216:219], v[156:159], v[16:31]
    ds_read_b64_tr_b16 v[212:213], v11 offset:32
    ds_read_b64_tr_b16 v[214:215], v11 offset:800
    s_waitcnt lgkmcnt(12)
    v_mfma_f32_32x32x16_bf16 v[32:47], v[220:223], v[156:159], v[32:47]
    ds_read_b64_tr_b16 v[216:217], v11 offset:64
    ds_read_b64_tr_b16 v[218:219], v11 offset:832
    s_waitcnt lgkmcnt(12)
    v_mfma_f32_32x32x16_bf16 v[48:63], v[224:227], v[156:159], v[48:63]
    ds_read_b64_tr_b16 v[220:221], v11 offset:96
    ds_read_b64_tr_b16 v[222:223], v11 offset:864
    buffer_load_dwordx4 v[152:155], v2, s[64:67], s5 offen offset:2048 sc1
    s_waitcnt lgkmcnt(12)
    v_mfma_f32_32x32x16_bf16 v[64:79], v[228:231], v[156:159], v[64:79]
    ds_read_b64_tr_b16 v[224:225], v11 offset:128
    ds_read_b64_tr_b16 v[226:227], v11 offset:896
    s_waitcnt lgkmcnt(12)
    v_mfma_f32_32x32x16_bf16 v[80:95], v[232:235], v[156:159], v[80:95]
    ds_read_b64_tr_b16 v[228:229], v11 offset:160
    ds_read_b64_tr_b16 v[230:231], v11 offset:928
    s_waitcnt lgkmcnt(12)
    v_mfma_f32_32x32x16_bf16 v[96:111], v[236:239], v[156:159], v[96:111]
    ds_read_b64_tr_b16 v[232:233], v11 offset:3072
    ds_read_b64_tr_b16 v[234:235], v11 offset:3840
    s_waitcnt lgkmcnt(12) vmcnt(18)
    v_mfma_f32_32x32x16_bf16 v[16:31], v[208:211], v[160:163], v[16:31]
    ds_read_b64_tr_b16 v[236:237], v11 offset:3104
    ds_read_b64_tr_b16 v[238:239], v11 offset:3872
    s_waitcnt lgkmcnt(12)
    v_mfma_f32_32x32x16_bf16 v[32:47], v[212:215], v[160:163], v[32:47]
    ds_read_b64_tr_b16 v[208:209], v11 offset:3136
    ds_read_b64_tr_b16 v[210:211], v11 offset:3904
    s_waitcnt lgkmcnt(12)
    v_mfma_f32_32x32x16_bf16 v[48:63], v[216:219], v[160:163], v[48:63]
    ds_read_b64_tr_b16 v[212:213], v11 offset:3168
    ds_read_b64_tr_b16 v[214:215], v11 offset:3936
    buffer_load_dwordx4 v[156:159], v2, s[64:67], s5 offen offset:3072 sc1
    s_waitcnt lgkmcnt(12)
    v_mfma_f32_32x32x16_bf16 v[64:79], v[220:223], v[160:163], v[64:79]
    ds_read_b64_tr_b16 v[216:217], v11 offset:3200
    ds_read_b64_tr_b16 v[218:219], v11 offset:3968
    s_waitcnt lgkmcnt(12)
    v_mfma_f32_32x32x16_bf16 v[80:95], v[224:227], v[160:163], v[80:95]
    ds_read_b64_tr_b16 v[220:221], v11 offset:3232
    ds_read_b64_tr_b16 v[222:223], v11 offset:4000
    s_waitcnt lgkmcnt(12)
    v_mfma_f32_32x32x16_bf16 v[96:111], v[228:231], v[160:163], v[96:111]
    ds_read_b64_tr_b16 v[224:225], v11 offset:6144
    ds_read_b64_tr_b16 v[226:227], v11 offset:6912
    s_waitcnt lgkmcnt(12) vmcnt(18)
    v_mfma_f32_32x32x16_bf16 v[16:31], v[232:235], v[164:167], v[16:31]
    ds_read_b64_tr_b16 v[228:229], v11 offset:6176
    ds_read_b64_tr_b16 v[230:231], v11 offset:6944
    s_waitcnt lgkmcnt(12)
    v_mfma_f32_32x32x16_bf16 v[32:47], v[236:239], v[164:167], v[32:47]
    ds_read_b64_tr_b16 v[232:233], v11 offset:6208
    ds_read_b64_tr_b16 v[234:235], v11 offset:6976
    s_waitcnt lgkmcnt(12)
    v_mfma_f32_32x32x16_bf16 v[48:63], v[208:211], v[164:167], v[48:63]
    ds_read_b64_tr_b16 v[236:237], v11 offset:6240
    ds_read_b64_tr_b16 v[238:239], v11 offset:7008
    s_add_u32 s5, s5, 4096
    buffer_load_dwordx4 v[160:163], v2, s[64:67], s5 offen offset:0 sc1
    s_waitcnt lgkmcnt(12)
    v_mfma_f32_32x32x16_bf16 v[64:79], v[212:215], v[164:167], v[64:79]
    ds_read_b64_tr_b16 v[208:209], v11 offset:6272
    ds_read_b64_tr_b16 v[210:211], v11 offset:7040
    s_waitcnt lgkmcnt(12)
    v_mfma_f32_32x32x16_bf16 v[80:95], v[216:219], v[164:167], v[80:95]
    ds_read_b64_tr_b16 v[212:213], v11 offset:6304
    ds_read_b64_tr_b16 v[214:215], v11 offset:7072
    s_waitcnt lgkmcnt(12)
    v_mfma_f32_32x32x16_bf16 v[96:111], v[220:223], v[164:167], v[96:111]
    ds_read_b64_tr_b16 v[216:217], v11 offset:9216
    ds_read_b64_tr_b16 v[218:219], v11 offset:9984
    s_waitcnt lgkmcnt(12) vmcnt(18)
    v_mfma_f32_32x32x16_bf16 v[16:31], v[224:227], v[168:171], v[16:31]
    ds_read_b64_tr_b16 v[220:221], v11 offset:9248
    ds_read_b64_tr_b16 v[222:223], v11 offset:10016
    s_waitcnt lgkmcnt(12)
    v_mfma_f32_32x32x16_bf16 v[32:47], v[228:231], v[168:171], v[32:47]
    ds_read_b64_tr_b16 v[224:225], v11 offset:9280
    ds_read_b64_tr_b16 v[226:227], v11 offset:10048
    s_waitcnt lgkmcnt(12)
    v_mfma_f32_32x32x16_bf16 v[48:63], v[232:235], v[168:171], v[48:63]
    ds_read_b64_tr_b16 v[228:229], v11 offset:9312
    ds_read_b64_tr_b16 v[230:231], v11 offset:10080
    buffer_load_dwordx4 v[164:167], v2, s[64:67], s5 offen offset:1024 sc1
    s_waitcnt lgkmcnt(12)
    v_mfma_f32_32x32x16_bf16 v[64:79], v[236:239], v[168:171], v[64:79]
    ds_read_b64_tr_b16 v[232:233], v11 offset:9344
    ds_read_b64_tr_b16 v[234:235], v11 offset:10112
    s_waitcnt lgkmcnt(12)
    v_mfma_f32_32x32x16_bf16 v[80:95], v[208:211], v[168:171], v[80:95]
    ds_read_b64_tr_b16 v[236:237], v11 offset:9376
    ds_read_b64_tr_b16 v[238:239], v11 offset:10144
    s_waitcnt lgkmcnt(12)
    v_mfma_f32_32x32x16_bf16 v[96:111], v[212:215], v[168:171], v[96:111]
    s_barrier
    ds_read_b64_tr_b16 v[208:209], v12 offset:0
    ds_read_b64_tr_b16 v[210:211], v12 offset:768
    s_waitcnt lgkmcnt(12) vmcnt(18)
    v_mfma_f32_32x32x16_bf16 v[16:31], v[216:219], v[172:175], v[16:31]
    ds_read_b64_tr_b16 v[212:213], v12 offset:32
    ds_read_b64_tr_b16 v[214:215], v12 offset:800
    s_waitcnt lgkmcnt(12)
    v_mfma_f32_32x32x16_bf16 v[32:47], v[220:223], v[172:175], v[32:47]
    ds_read_b64_tr_b16 v[216:217], v12 offset:64
    ds_read_b64_tr_b16 v[218:219], v12 offset:832
    s_waitcnt lgkmcnt(12)
    v_mfma_f32_32x32x16_bf16 v[48:63], v[224:227], v[172:175], v[48:63]
    ds_read_b64_tr_b16 v[220:221], v12 offset:96
    ds_read_b64_tr_b16 v[222:223], v12 offset:864
    buffer_load_dwordx4 v[168:171], v2, s[64:67], s5 offen offset:2048 sc1
    s_waitcnt lgkmcnt(12)
    v_mfma_f32_32x32x16_bf16 v[64:79], v[228:231], v[172:175], v[64:79]
    ds_read_b64_tr_b16 v[224:225], v12 offset:128
    ds_read_b64_tr_b16 v[226:227], v12 offset:896
    s_waitcnt lgkmcnt(12)
    v_mfma_f32_32x32x16_bf16 v[80:95], v[232:235], v[172:175], v[80:95]
    ds_read_b64_tr_b16 v[228:229], v12 offset:160
    ds_read_b64_tr_b16 v[230:231], v12 offset:928
    s_waitcnt lgkmcnt(12)
    v_mfma_f32_32x32x16_bf16 v[96:111], v[236:239], v[172:175], v[96:111]
    ds_read_b64_tr_b16 v[232:233], v12 offset:3072
    ds_read_b64_tr_b16 v[234:235], v12 offset:3840
    s_waitcnt lgkmcnt(12) vmcnt(18)
    v_mfma_f32_32x32x16_bf16 v[16:31], v[208:211], v[176:179], v[16:31]
    ds_read_b64_tr_b16 v[236:237], v12 offset:3104
    ds_read_b64_tr_b16 v[238:239], v12 offset:3872
    s_waitcnt lgkmcnt(12)
    v_mfma_f32_32x32x16_bf16 v[32:47], v[212:215], v[176:179], v[32:47]
    ds_read_b64_tr_b16 v[208:209], v12 offset:3136
    ds_read_b64_tr_b16 v[210:211], v12 offset:3904
    s_waitcnt lgkmcnt(12)
    v_mfma_f32_32x32x16_bf16 v[48:63], v[216:219], v[176:179], v[48:63]
    ds_read_b64_tr_b16 v[212:213], v12 offset:3168
    ds_read_b64_tr_b16 v[214:215], v12 offset:3936
    buffer_load_dwordx4 v[172:175], v2, s[64:67], s5 offen offset:3072 sc1
    s_waitcnt lgkmcnt(12)
    v_mfma_f32_32x32x16_bf16 v[64:79], v[220:223], v[176:179], v[64:79]
    ds_read_b64_tr_b16 v[216:217], v12 offset:3200
    ds_read_b64_tr_b16 v[218:219], v12 offset:3968
    s_waitcnt lgkmcnt(12)
    v_mfma_f32_32x32x16_bf16 v[80:95], v[224:227], v[176:179], v[80:95]
    ds_read_b64_tr_b16 v[220:221], v12 offset:3232
    ds_read_b64_tr_b16 v[222:223], v12 offset:4000
    s_waitcnt lgkmcnt(12)
    v_mfma_f32_32x32x16_bf16 v[96:111], v[228:231], v[176:179], v[96:111]
    ds_read_b64_tr_b16 v[224:225], v12 offset:6144
    ds_read_b64_tr_b16 v[226:227], v12 offset:6912
    s_waitcnt lgkmcnt(12) vmcnt(18)
    v_mfma_f32_32x32x16_bf16 v[16:31], v[232:235], v[180:183], v[16:31]
    ds_read_b64_tr_b16 v[228:229], v12 offset:6176
    ds_read_b64_tr_b16 v[230:231], v12 offset:6944
    s_waitcnt lgkmcnt(12)
    v_mfma_f32_32x32x16_bf16 v[32:47], v[236:239], v[180:183], v[32:47]
    ds_read_b64_tr_b16 v[232:233], v12 offset:6208
    ds_read_b64_tr_b16 v[234:235], v12 offset:6976
    s_waitcnt lgkmcnt(12)
    v_mfma_f32_32x32x16_bf16 v[48:63], v[208:211], v[180:183], v[48:63]
    ds_read_b64_tr_b16 v[236:237], v12 offset:6240
    ds_read_b64_tr_b16 v[238:239], v12 offset:7008
    s_waitcnt lgkmcnt(12)
    v_mfma_f32_32x32x16_bf16 v[64:79], v[212:215], v[180:183], v[64:79]
    ds_read_b64_tr_b16 v[208:209], v12 offset:6272
    ds_read_b64_tr_b16 v[210:211], v12 offset:7040
    s_waitcnt lgkmcnt(12)
    v_mfma_f32_32x32x16_bf16 v[80:95], v[216:219], v[180:183], v[80:95]
    ds_read_b64_tr_b16 v[212:213], v12 offset:6304
    ds_read_b64_tr_b16 v[214:215], v12 offset:7072
    s_waitcnt lgkmcnt(12)
    v_mfma_f32_32x32x16_bf16 v[96:111], v[220:223], v[180:183], v[96:111]
    ds_read_b64_tr_b16 v[216:217], v12 offset:9216
    ds_read_b64_tr_b16 v[218:219], v12 offset:9984
    s_waitcnt lgkmcnt(12) vmcnt(17)
    v_mfma_f32_32x32x16_bf16 v[16:31], v[224:227], v[184:187], v[16:31]
    ds_read_b64_tr_b16 v[220:221], v12 offset:9248
    ds_read_b64_tr_b16 v[222:223], v12 offset:10016
    s_waitcnt lgkmcnt(12)
    v_mfma_f32_32x32x16_bf16 v[32:47], v[228:231], v[184:187], v[32:47]
    ds_read_b64_tr_b16 v[224:225], v12 offset:9280
    ds_read_b64_tr_b16 v[226:227], v12 offset:10048
    s_waitcnt lgkmcnt(12)
    v_mfma_f32_32x32x16_bf16 v[48:63], v[232:235], v[184:187], v[48:63]
    ds_read_b64_tr_b16 v[228:229], v12 offset:9312
    ds_read_b64_tr_b16 v[230:231], v12 offset:10080
    s_waitcnt lgkmcnt(12)
    v_mfma_f32_32x32x16_bf16 v[64:79], v[236:239], v[184:187], v[64:79]
    ds_read_b64_tr_b16 v[232:233], v12 offset:9344
    ds_read_b64_tr_b16 v[234:235], v12 offset:10112
    s_waitcnt lgkmcnt(12)
    v_mfma_f32_32x32x16_bf16 v[80:95], v[208:211], v[184:187], v[80:95]
    ds_read_b64_tr_b16 v[236:237], v12 offset:9376
    ds_read_b64_tr_b16 v[238:239], v12 offset:10144
    s_waitcnt lgkmcnt(12)
    v_mfma_f32_32x32x16_bf16 v[96:111], v[212:215], v[184:187], v[96:111]
    s_barrier
    ds_read_b64_tr_b16 v[208:209], v13 offset:0
    ds_read_b64_tr_b16 v[210:211], v13 offset:768
    s_waitcnt lgkmcnt(12) vmcnt(16)
    v_mfma_f32_32x32x16_bf16 v[16:31], v[216:219], v[188:191], v[16:31]
    ds_read_b64_tr_b16 v[212:213], v13 offset:32
    ds_read_b64_tr_b16 v[214:215], v13 offset:800
    s_waitcnt lgkmcnt(12)
    v_mfma_f32_32x32x16_bf16 v[32:47], v[220:223], v[188:191], v[32:47]
    ds_read_b64_tr_b16 v[216:217], v13 offset:64
    ds_read_b64_tr_b16 v[218:219], v13 offset:832
    s_waitcnt lgkmcnt(12)
    v_mfma_f32_32x32x16_bf16 v[48:63], v[224:227], v[188:191], v[48:63]
    ds_read_b64_tr_b16 v[220:221], v13 offset:96
    ds_read_b64_tr_b16 v[222:223], v13 offset:864
    s_waitcnt lgkmcnt(12)
    v_mfma_f32_32x32x16_bf16 v[64:79], v[228:231], v[188:191], v[64:79]
    ds_read_b64_tr_b16 v[224:225], v13 offset:128
    ds_read_b64_tr_b16 v[226:227], v13 offset:896
    s_waitcnt lgkmcnt(12)
    v_mfma_f32_32x32x16_bf16 v[80:95], v[232:235], v[188:191], v[80:95]
    ds_read_b64_tr_b16 v[228:229], v13 offset:160
    ds_read_b64_tr_b16 v[230:231], v13 offset:928
    s_waitcnt lgkmcnt(12)
    v_mfma_f32_32x32x16_bf16 v[96:111], v[236:239], v[188:191], v[96:111]
    ds_read_b64_tr_b16 v[232:233], v13 offset:3072
    ds_read_b64_tr_b16 v[234:235], v13 offset:3840
    s_waitcnt lgkmcnt(12) vmcnt(15)
    v_mfma_f32_32x32x16_bf16 v[16:31], v[208:211], v[192:195], v[16:31]
    ds_read_b64_tr_b16 v[236:237], v13 offset:3104
    ds_read_b64_tr_b16 v[238:239], v13 offset:3872
    s_waitcnt lgkmcnt(12)
    v_mfma_f32_32x32x16_bf16 v[32:47], v[212:215], v[192:195], v[32:47]
    ds_read_b64_tr_b16 v[208:209], v13 offset:3136
    ds_read_b64_tr_b16 v[210:211], v13 offset:3904
    s_waitcnt lgkmcnt(12)
    v_mfma_f32_32x32x16_bf16 v[48:63], v[216:219], v[192:195], v[48:63]
    ds_read_b64_tr_b16 v[212:213], v13 offset:3168
    ds_read_b64_tr_b16 v[214:215], v13 offset:3936
    s_waitcnt lgkmcnt(12)
    v_mfma_f32_32x32x16_bf16 v[64:79], v[220:223], v[192:195], v[64:79]
    ds_read_b64_tr_b16 v[216:217], v13 offset:3200
    ds_read_b64_tr_b16 v[218:219], v13 offset:3968
    s_waitcnt lgkmcnt(12)
    v_mfma_f32_32x32x16_bf16 v[80:95], v[224:227], v[192:195], v[80:95]
    ds_read_b64_tr_b16 v[220:221], v13 offset:3232
    ds_read_b64_tr_b16 v[222:223], v13 offset:4000
    s_waitcnt lgkmcnt(12)
    v_mfma_f32_32x32x16_bf16 v[96:111], v[228:231], v[192:195], v[96:111]
    ds_read_b64_tr_b16 v[224:225], v13 offset:6144
    ds_read_b64_tr_b16 v[226:227], v13 offset:6912
    s_waitcnt lgkmcnt(12) vmcnt(14)
    v_mfma_f32_32x32x16_bf16 v[16:31], v[232:235], v[196:199], v[16:31]
    ds_read_b64_tr_b16 v[228:229], v13 offset:6176
    ds_read_b64_tr_b16 v[230:231], v13 offset:6944
    s_waitcnt lgkmcnt(12)
    v_mfma_f32_32x32x16_bf16 v[32:47], v[236:239], v[196:199], v[32:47]
    ds_read_b64_tr_b16 v[232:233], v13 offset:6208
    ds_read_b64_tr_b16 v[234:235], v13 offset:6976
    s_waitcnt lgkmcnt(12)
    v_mfma_f32_32x32x16_bf16 v[48:63], v[208:211], v[196:199], v[48:63]
    ds_read_b64_tr_b16 v[236:237], v13 offset:6240
    ds_read_b64_tr_b16 v[238:239], v13 offset:7008
    s_waitcnt lgkmcnt(12)
    v_mfma_f32_32x32x16_bf16 v[64:79], v[212:215], v[196:199], v[64:79]
    ds_read_b64_tr_b16 v[208:209], v13 offset:6272
    ds_read_b64_tr_b16 v[210:211], v13 offset:7040
    s_waitcnt lgkmcnt(12)
    v_mfma_f32_32x32x16_bf16 v[80:95], v[216:219], v[196:199], v[80:95]
    ds_read_b64_tr_b16 v[212:213], v13 offset:6304
    ds_read_b64_tr_b16 v[214:215], v13 offset:7072
    s_waitcnt lgkmcnt(12)
    v_mfma_f32_32x32x16_bf16 v[96:111], v[220:223], v[196:199], v[96:111]
    ds_read_b64_tr_b16 v[216:217], v13 offset:9216
    ds_read_b64_tr_b16 v[218:219], v13 offset:9984
    s_waitcnt lgkmcnt(12) vmcnt(13)
    v_mfma_f32_32x32x16_bf16 v[16:31], v[224:227], v[200:203], v[16:31]
    ds_read_b64_tr_b16 v[220:221], v13 offset:9248
    ds_read_b64_tr_b16 v[222:223], v13 offset:10016
    s_waitcnt lgkmcnt(12)
    v_mfma_f32_32x32x16_bf16 v[32:47], v[228:231], v[200:203], v[32:47]
    ds_read_b64_tr_b16 v[224:225], v13 offset:9280
    ds_read_b64_tr_b16 v[226:227], v13 offset:10048
    s_waitcnt lgkmcnt(12)
    v_mfma_f32_32x32x16_bf16 v[48:63], v[232:235], v[200:203], v[48:63]
    ds_read_b64_tr_b16 v[228:229], v13 offset:9312
    ds_read_b64_tr_b16 v[230:231], v13 offset:10080
    s_waitcnt lgkmcnt(12)
    v_mfma_f32_32x32x16_bf16 v[64:79], v[236:239], v[200:203], v[64:79]
    ds_read_b64_tr_b16 v[232:233], v13 offset:9344
    ds_read_b64_tr_b16 v[234:235], v13 offset:10112
    s_waitcnt lgkmcnt(12)
    v_mfma_f32_32x32x16_bf16 v[80:95], v[208:211], v[200:203], v[80:95]
    ds_read_b64_tr_b16 v[236:237], v13 offset:9376
    ds_read_b64_tr_b16 v[238:239], v13 offset:10144
    s_waitcnt lgkmcnt(12)
    v_mfma_f32_32x32x16_bf16 v[96:111], v[212:215], v[200:203], v[96:111]
    s_barrier
    ds_read_b64_tr_b16 v[208:209], v9 offset:0
    ds_read_b64_tr_b16 v[210:211], v9 offset:768
    s_waitcnt lgkmcnt(12) vmcnt(12)
    v_mfma_f32_32x32x16_bf16 v[16:31], v[216:219], v[204:207], v[16:31]
    ds_read_b64_tr_b16 v[212:213], v9 offset:3072
    ds_read_b64_tr_b16 v[214:215], v9 offset:3840
    s_waitcnt lgkmcnt(12)
    v_mfma_f32_32x32x16_bf16 v[32:47], v[220:223], v[204:207], v[32:47]
    ds_read_b64_tr_b16 v[216:217], v9 offset:6144
    ds_read_b64_tr_b16 v[218:219], v9 offset:6912
    s_waitcnt lgkmcnt(12)
    v_mfma_f32_32x32x16_bf16 v[48:63], v[224:227], v[204:207], v[48:63]
    ds_read_b64_tr_b16 v[220:221], v9 offset:9216
    ds_read_b64_tr_b16 v[222:223], v9 offset:9984
    s_waitcnt lgkmcnt(12)
    v_mfma_f32_32x32x16_bf16 v[64:79], v[228:231], v[204:207], v[64:79]
    s_barrier
    ds_read_b64_tr_b16 v[224:225], v10 offset:0
    ds_read_b64_tr_b16 v[226:227], v10 offset:768
    s_waitcnt lgkmcnt(12)
    v_mfma_f32_32x32x16_bf16 v[80:95], v[232:235], v[204:207], v[80:95]
    ds_read_b64_tr_b16 v[228:229], v10 offset:3072
    ds_read_b64_tr_b16 v[230:231], v10 offset:3840
    s_waitcnt lgkmcnt(12)
    v_mfma_f32_32x32x16_bf16 v[96:111], v[236:239], v[204:207], v[96:111]
    ds_read_b64_tr_b16 v[232:233], v10 offset:6144
    ds_read_b64_tr_b16 v[234:235], v10 offset:6912
    s_waitcnt lgkmcnt(12) vmcnt(11)
    v_mfma_f32_32x32x16_bf16 v[16:31], v[208:211], v[128:131], v[16:31]
    ds_read_b64_tr_b16 v[236:237], v10 offset:9216
    ds_read_b64_tr_b16 v[238:239], v10 offset:9984
    s_waitcnt lgkmcnt(12) vmcnt(10)
    v_mfma_f32_32x32x16_bf16 v[16:31], v[212:215], v[132:135], v[16:31]
    s_barrier
    ds_read_b64_tr_b16 v[208:209], v11 offset:0
    ds_read_b64_tr_b16 v[210:211], v11 offset:768
    s_waitcnt lgkmcnt(12) vmcnt(9)
    v_mfma_f32_32x32x16_bf16 v[16:31], v[216:219], v[136:139], v[16:31]
    ds_read_b64_tr_b16 v[212:213], v11 offset:3072
    ds_read_b64_tr_b16 v[214:215], v11 offset:3840
    s_waitcnt lgkmcnt(12) vmcnt(8)
    v_mfma_f32_32x32x16_bf16 v[16:31], v[220:223], v[140:143], v[16:31]
    ds_read_b64_tr_b16 v[216:217], v11 offset:6144
    ds_read_b64_tr_b16 v[218:219], v11 offset:6912
    s_waitcnt lgkmcnt(12) vmcnt(7)
    v_mfma_f32_32x32x16_bf16 v[16:31], v[224:227], v[144:147], v[16:31]
    ds_read_b64_tr_b16 v[220:221], v11 offset:9216
    ds_read_b64_tr_b16 v[222:223], v11 offset:9984
    s_waitcnt lgkmcnt(12) vmcnt(6)
    v_mfma_f32_32x32x16_bf16 v[16:31], v[228:231], v[148:151], v[16:31]
    ds_read_b64_tr_b16 v[224:225], v9 offset:32
    ds_read_b64_tr_b16 v[226:227], v9 offset:800
    s_waitcnt lgkmcnt(12) vmcnt(5)
    v_mfma_f32_32x32x16_bf16 v[16:31], v[232:235], v[152:155], v[16:31]
    ds_read_b64_tr_b16 v[228:229], v9 offset:3104
    ds_read_b64_tr_b16 v[230:231], v9 offset:3872
    s_waitcnt lgkmcnt(12) vmcnt(4)
    v_mfma_f32_32x32x16_bf16 v[16:31], v[236:239], v[156:159], v[16:31]
    ds_read_b64_tr_b16 v[232:233], v9 offset:6176
    ds_read_b64_tr_b16 v[234:235], v9 offset:6944
    s_waitcnt lgkmcnt(12) vmcnt(3)
    v_mfma_f32_32x32x16_bf16 v[16:31], v[208:211], v[160:163], v[16:31]
    ds_read_b64_tr_b16 v[236:237], v9 offset:9248
    ds_read_b64_tr_b16 v[238:239], v9 offset:10016
    s_waitcnt lgkmcnt(12) vmcnt(2)
    v_mfma_f32_32x32x16_bf16 v[16:31], v[212:215], v[164:167], v[16:31]
    ds_read_b64_tr_b16 v[208:209], v10 offset:32
    ds_read_b64_tr_b16 v[210:211], v10 offset:800
    s_waitcnt lgkmcnt(12) vmcnt(1)
    v_mfma_f32_32x32x16_bf16 v[16:31], v[216:219], v[168:171], v[16:31]
    ds_read_b64_tr_b16 v[212:213], v10 offset:3104
    ds_read_b64_tr_b16 v[214:215], v10 offset:3872
    s_waitcnt lgkmcnt(12) vmcnt(0)
    v_mfma_f32_32x32x16_bf16 v[16:31], v[220:223], v[172:175], v[16:31]
    ds_read_b64_tr_b16 v[216:217], v10 offset:6176
    ds_read_b64_tr_b16 v[218:219], v10 offset:6944
    s_waitcnt lgkmcnt(12)
    v_mfma_f32_32x32x16_bf16 v[32:47], v[224:227], v[128:131], v[32:47]
    ds_read_b64_tr_b16 v[220:221], v10 offset:9248
    ds_read_b64_tr_b16 v[222:223], v10 offset:10016
    s_waitcnt lgkmcnt(12)
    v_mfma_f32_32x32x16_bf16 v[32:47], v[228:231], v[132:135], v[32:47]
    ds_read_b64_tr_b16 v[224:225], v11 offset:32
    ds_read_b64_tr_b16 v[226:227], v11 offset:800
    s_waitcnt lgkmcnt(12)
    v_mfma_f32_32x32x16_bf16 v[32:47], v[232:235], v[136:139], v[32:47]
    ds_read_b64_tr_b16 v[228:229], v11 offset:3104
    ds_read_b64_tr_b16 v[230:231], v11 offset:3872
    v_cvt_pk_bf16_f32 v240, 0, v16
    v_cvt_pk_bf16_f32 v241, 0, v17
    v_cvt_pk_bf16_f32 v242, 0, v18
    v_cvt_pk_bf16_f32 v243, 0, v19
    v_cvt_pk_bf16_f32 v244, 0, v20
    s_waitcnt lgkmcnt(12)
    v_mfma_f32_32x32x16_bf16 v[32:47], v[236:239], v[140:143], v[32:47]
    ds_read_b64_tr_b16 v[232:233], v11 offset:6176
    ds_read_b64_tr_b16 v[234:235], v11 offset:6944
    v_cvt_pk_bf16_f32 v245, 0, v21
    v_cvt_pk_bf16_f32 v246, 0, v22
    v_cvt_pk_bf16_f32 v247, 0, v23
    v_mul_f32 v248, s12, v240
    v_mul_f32 v249, s12, v241
    s_waitcnt lgkmcnt(12)
    v_mfma_f32_32x32x16_bf16 v[32:47], v[208:211], v[144:147], v[32:47]
    ds_read_b64_tr_b16 v[236:237], v11 offset:9248
    ds_read_b64_tr_b16 v[238:239], v11 offset:10016
    v_mul_f32 v250, s12, v242
    v_mul_f32 v251, s12, v243
    v_mul_f32 v252, s12, v244
    v_mul_f32 v253, s12, v245
    v_mul_f32 v254, s12, v246
    s_waitcnt lgkmcnt(12)
    v_mfma_f32_32x32x16_bf16 v[32:47], v[212:215], v[148:151], v[32:47]
    ds_read_b64_tr_b16 v[208:209], v9 offset:64
    ds_read_b64_tr_b16 v[210:211], v9 offset:832
    v_mul_f32 v255, s12, v247
    v_exp_f32 v248, v248
    v_exp_f32 v249, v249
    s_waitcnt lgkmcnt(12)
    v_mfma_f32_32x32x16_bf16 v[32:47], v[216:219], v[152:155], v[32:47]
    ds_read_b64_tr_b16 v[212:213], v9 offset:3136
    ds_read_b64_tr_b16 v[214:215], v9 offset:3904
    v_exp_f32 v250, v250
    v_exp_f32 v251, v251
    v_exp_f32 v252, v252
    s_waitcnt lgkmcnt(12)
    v_mfma_f32_32x32x16_bf16 v[32:47], v[220:223], v[156:159], v[32:47]
    ds_read_b64_tr_b16 v[216:217], v9 offset:6208
    ds_read_b64_tr_b16 v[218:219], v9 offset:6976
    v_exp_f32 v253, v253
    v_exp_f32 v254, v254
    v_exp_f32 v255, v255
    s_waitcnt lgkmcnt(12)
    v_mfma_f32_32x32x16_bf16 v[32:47], v[224:227], v[160:163], v[32:47]
    ds_read_b64_tr_b16 v[220:221], v9 offset:9280
    ds_read_b64_tr_b16 v[222:223], v9 offset:10048
    v_add_f32 v248, 1.0, v248
    v_add_f32 v249, 1.0, v249
    v_add_f32 v250, 1.0, v250
    v_add_f32 v251, 1.0, v251
    v_add_f32 v252, 1.0, v252
    s_waitcnt lgkmcnt(12)
    v_mfma_f32_32x32x16_bf16 v[32:47], v[228:231], v[164:167], v[32:47]
    ds_read_b64_tr_b16 v[224:225], v10 offset:64
    ds_read_b64_tr_b16 v[226:227], v10 offset:832
    v_add_f32 v253, 1.0, v253
    v_add_f32 v254, 1.0, v254
    v_add_f32 v255, 1.0, v255
    v_rcp_f32 v248, v248
    s_waitcnt lgkmcnt(12)
    v_mfma_f32_32x32x16_bf16 v[32:47], v[232:235], v[168:171], v[32:47]
    ds_read_b64_tr_b16 v[228:229], v10 offset:3136
    ds_read_b64_tr_b16 v[230:231], v10 offset:3904
    v_rcp_f32 v249, v249
    v_rcp_f32 v250, v250
    v_rcp_f32 v251, v251
    s_waitcnt lgkmcnt(12)
    v_mfma_f32_32x32x16_bf16 v[32:47], v[236:239], v[172:175], v[32:47]
    ds_read_b64_tr_b16 v[232:233], v10 offset:6208
    ds_read_b64_tr_b16 v[234:235], v10 offset:6976
    v_rcp_f32 v252, v252
    v_rcp_f32 v253, v253
    v_rcp_f32 v254, v254
    s_waitcnt lgkmcnt(12)
    v_mfma_f32_32x32x16_bf16 v[48:63], v[208:211], v[128:131], v[48:63]
    ds_read_b64_tr_b16 v[236:237], v10 offset:9280
    ds_read_b64_tr_b16 v[238:239], v10 offset:10048
    v_rcp_f32 v255, v255
    v_mul_f32 v240, v248, v240
    v_mul_f32 v241, v249, v241
    v_mul_f32 v242, v250, v242
    s_waitcnt lgkmcnt(12)
    v_mfma_f32_32x32x16_bf16 v[48:63], v[212:215], v[132:135], v[48:63]
    ds_read_b64_tr_b16 v[208:209], v11 offset:64
    ds_read_b64_tr_b16 v[210:211], v11 offset:832
    v_mul_f32 v243, v251, v243
    v_mul_f32 v244, v252, v244
    v_mul_f32 v245, v253, v245
    v_mul_f32 v246, v254, v246
    v_mul_f32 v247, v255, v247
    s_waitcnt lgkmcnt(12)
    v_mfma_f32_32x32x16_bf16 v[48:63], v[216:219], v[136:139], v[48:63]
    ds_read_b64_tr_b16 v[212:213], v11 offset:3136
    ds_read_b64_tr_b16 v[214:215], v11 offset:3904
    v_cvt_pk_bf16_f32 v248, 0, v24
    v_cvt_pk_bf16_f32 v249, 0, v25
    v_cvt_pk_bf16_f32 v250, 0, v26
    v_cvt_pk_bf16_f32 v251, 0, v27
    v_cvt_pk_bf16_f32 v252, 0, v28
    s_waitcnt lgkmcnt(12)
    v_mfma_f32_32x32x16_bf16 v[48:63], v[220:223], v[140:143], v[48:63]
    ds_read_b64_tr_b16 v[216:217], v11 offset:6208
    ds_read_b64_tr_b16 v[218:219], v11 offset:6976
    v_cvt_pk_bf16_f32 v253, 0, v29
    v_cvt_pk_bf16_f32 v254, 0, v30
    v_cvt_pk_bf16_f32 v255, 0, v31
    v_cvt_pk_bf16_f32 v240, 0, v240
    v_cvt_pk_bf16_f32 v241, 0, v241
    s_waitcnt lgkmcnt(12)
    v_mfma_f32_32x32x16_bf16 v[48:63], v[224:227], v[144:147], v[48:63]
    ds_read_b64_tr_b16 v[220:221], v11 offset:9280
    ds_read_b64_tr_b16 v[222:223], v11 offset:10048
    v_cvt_pk_bf16_f32 v242, 0, v242
    v_cvt_pk_bf16_f32 v243, 0, v243
    v_cvt_pk_bf16_f32 v244, 0, v244
    v_cvt_pk_bf16_f32 v245, 0, v245
    v_cvt_pk_bf16_f32 v246, 0, v246
    s_waitcnt lgkmcnt(12)
    v_mfma_f32_32x32x16_bf16 v[48:63], v[228:231], v[148:151], v[48:63]
    ds_read_b64_tr_b16 v[224:225], v9 offset:96
    ds_read_b64_tr_b16 v[226:227], v9 offset:864
    v_cvt_pk_bf16_f32 v247, 0, v247
    v_mul_f32 v240, v248, v240
    v_mul_f32 v241, v249, v241
    v_mul_f32 v242, v250, v242
    v_mul_f32 v243, v251, v243
    s_waitcnt lgkmcnt(12)
    v_mfma_f32_32x32x16_bf16 v[48:63], v[232:235], v[152:155], v[48:63]
    ds_read_b64_tr_b16 v[228:229], v9 offset:3168
    ds_read_b64_tr_b16 v[230:231], v9 offset:3936
    v_mul_f32 v244, v252, v244
    v_mul_f32 v245, v253, v245
    v_mul_f32 v246, v254, v246
    v_mul_f32 v247, v255, v247
    v_cvt_pk_bf16_f32 v16, v240, v241
    s_waitcnt lgkmcnt(12)
    v_mfma_f32_32x32x16_bf16 v[48:63], v[236:239], v[156:159], v[48:63]
    ds_read_b64_tr_b16 v[232:233], v9 offset:6240
    ds_read_b64_tr_b16 v[234:235], v9 offset:7008
    v_cvt_pk_bf16_f32 v17, v242, v243
    v_cvt_pk_bf16_f32 v18, v244, v245
    v_cvt_pk_bf16_f32 v19, v246, v247
    buffer_store_dwordx4 v[16:19], v2, s[64:67], s14 offen offset:0 sc1
    v_cvt_pk_bf16_f32 v112, 0, v32
    s_waitcnt lgkmcnt(12)
    v_mfma_f32_32x32x16_bf16 v[48:63], v[208:211], v[160:163], v[48:63]
    ds_read_b64_tr_b16 v[236:237], v9 offset:9312
    ds_read_b64_tr_b16 v[238:239], v9 offset:10080
    v_cvt_pk_bf16_f32 v113, 0, v33
    v_cvt_pk_bf16_f32 v114, 0, v34
    v_cvt_pk_bf16_f32 v115, 0, v35
    v_cvt_pk_bf16_f32 v116, 0, v36
    v_cvt_pk_bf16_f32 v117, 0, v37
    s_waitcnt lgkmcnt(12)
    v_mfma_f32_32x32x16_bf16 v[48:63], v[212:215], v[164:167], v[48:63]
    ds_read_b64_tr_b16 v[208:209], v10 offset:96
    ds_read_b64_tr_b16 v[210:211], v10 offset:864
    v_cvt_pk_bf16_f32 v118, 0, v38
    v_cvt_pk_bf16_f32 v119, 0, v39
    v_mul_f32 v120, s12, v112
    v_mul_f32 v121, s12, v113
    v_mul_f32 v122, s12, v114
    s_waitcnt lgkmcnt(12)
    v_mfma_f32_32x32x16_bf16 v[48:63], v[216:219], v[168:171], v[48:63]
    ds_read_b64_tr_b16 v[212:213], v10 offset:3168
    ds_read_b64_tr_b16 v[214:215], v10 offset:3936
    v_mul_f32 v123, s12, v115
    v_mul_f32 v124, s12, v116
    v_mul_f32 v125, s12, v117
    v_mul_f32 v126, s12, v118
    v_mul_f32 v127, s12, v119
    s_waitcnt lgkmcnt(12)
    v_mfma_f32_32x32x16_bf16 v[48:63], v[220:223], v[172:175], v[48:63]
    ds_read_b64_tr_b16 v[216:217], v10 offset:6240
    ds_read_b64_tr_b16 v[218:219], v10 offset:7008
    v_exp_f32 v120, v120
    v_exp_f32 v121, v121
    v_exp_f32 v122, v122
    s_waitcnt lgkmcnt(12)
    v_mfma_f32_32x32x16_bf16 v[64:79], v[224:227], v[128:131], v[64:79]
    ds_read_b64_tr_b16 v[220:221], v10 offset:9312
    ds_read_b64_tr_b16 v[222:223], v10 offset:10080
    v_exp_f32 v123, v123
    v_exp_f32 v124, v124
    v_exp_f32 v125, v125
    s_waitcnt lgkmcnt(12)
    v_mfma_f32_32x32x16_bf16 v[64:79], v[228:231], v[132:135], v[64:79]
    ds_read_b64_tr_b16 v[224:225], v11 offset:96
    ds_read_b64_tr_b16 v[226:227], v11 offset:864
    v_exp_f32 v126, v126
    v_exp_f32 v127, v127
    v_add_f32 v120, 1.0, v120
    s_waitcnt lgkmcnt(12)
    v_mfma_f32_32x32x16_bf16 v[64:79], v[232:235], v[136:139], v[64:79]
    ds_read_b64_tr_b16 v[228:229], v11 offset:3168
    ds_read_b64_tr_b16 v[230:231], v11 offset:3936
    v_add_f32 v121, 1.0, v121
    v_add_f32 v122, 1.0, v122
    v_add_f32 v123, 1.0, v123
    v_add_f32 v124, 1.0, v124
    v_add_f32 v125, 1.0, v125
    s_waitcnt lgkmcnt(12)
    v_mfma_f32_32x32x16_bf16 v[64:79], v[236:239], v[140:143], v[64:79]
    ds_read_b64_tr_b16 v[232:233], v11 offset:6240
    ds_read_b64_tr_b16 v[234:235], v11 offset:7008
    v_add_f32 v126, 1.0, v126
    v_add_f32 v127, 1.0, v127
    v_rcp_f32 v120, v120
    v_rcp_f32 v121, v121
    s_waitcnt lgkmcnt(12)
    v_mfma_f32_32x32x16_bf16 v[64:79], v[208:211], v[144:147], v[64:79]
    ds_read_b64_tr_b16 v[236:237], v11 offset:9312
    ds_read_b64_tr_b16 v[238:239], v11 offset:10080
    v_rcp_f32 v122, v122
    v_rcp_f32 v123, v123
    v_rcp_f32 v124, v124
    s_waitcnt lgkmcnt(12)
    v_mfma_f32_32x32x16_bf16 v[64:79], v[212:215], v[148:151], v[64:79]
    ds_read_b64_tr_b16 v[208:209], v9 offset:128
    ds_read_b64_tr_b16 v[210:211], v9 offset:896
    v_rcp_f32 v125, v125
    v_rcp_f32 v126, v126
    v_rcp_f32 v127, v127
    s_waitcnt lgkmcnt(12)
    v_mfma_f32_32x32x16_bf16 v[64:79], v[216:219], v[152:155], v[64:79]
    ds_read_b64_tr_b16 v[212:213], v9 offset:3200
    ds_read_b64_tr_b16 v[214:215], v9 offset:3968
    v_mul_f32 v112, v120, v112
    v_mul_f32 v113, v121, v113
    v_mul_f32 v114, v122, v114
    v_mul_f32 v115, v123, v115
    v_mul_f32 v116, v124, v116
    s_waitcnt lgkmcnt(12)
    v_mfma_f32_32x32x16_bf16 v[64:79], v[220:223], v[156:159], v[64:79]
    ds_read_b64_tr_b16 v[216:217], v9 offset:6272
    ds_read_b64_tr_b16 v[218:219], v9 offset:7040
    v_mul_f32 v117, v125, v117
    v_mul_f32 v118, v126, v118
    v_mul_f32 v119, v127, v119
    v_cvt_pk_bf16_f32 v120, 0, v40
    v_cvt_pk_bf16_f32 v121, 0, v41
    s_waitcnt lgkmcnt(12)
    v_mfma_f32_32x32x16_bf16 v[64:79], v[224:227], v[160:163], v[64:79]
    ds_read_b64_tr_b16 v[220:221], v9 offset:9344
    ds_read_b64_tr_b16 v[222:223], v9 offset:10112
    v_cvt_pk_bf16_f32 v122, 0, v42
    v_cvt_pk_bf16_f32 v123, 0, v43
    v_cvt_pk_bf16_f32 v124, 0, v44
    v_cvt_pk_bf16_f32 v125, 0, v45
    v_cvt_pk_bf16_f32 v126, 0, v46
    s_waitcnt lgkmcnt(12)
    v_mfma_f32_32x32x16_bf16 v[64:79], v[228:231], v[164:167], v[64:79]
    ds_read_b64_tr_b16 v[224:225], v10 offset:128
    ds_read_b64_tr_b16 v[226:227], v10 offset:896
    v_cvt_pk_bf16_f32 v127, 0, v47
    v_cvt_pk_bf16_f32 v112, 0, v112
    v_cvt_pk_bf16_f32 v113, 0, v113
    v_cvt_pk_bf16_f32 v114, 0, v114
    v_cvt_pk_bf16_f32 v115, 0, v115
    s_waitcnt lgkmcnt(12)
    v_mfma_f32_32x32x16_bf16 v[64:79], v[232:235], v[168:171], v[64:79]
    ds_read_b64_tr_b16 v[228:229], v10 offset:3200
    ds_read_b64_tr_b16 v[230:231], v10 offset:3968
    v_cvt_pk_bf16_f32 v116, 0, v116
    v_cvt_pk_bf16_f32 v117, 0, v117
    v_cvt_pk_bf16_f32 v118, 0, v118
    v_cvt_pk_bf16_f32 v119, 0, v119
    v_mul_f32 v112, v120, v112
    s_waitcnt lgkmcnt(12)
    v_mfma_f32_32x32x16_bf16 v[64:79], v[236:239], v[172:175], v[64:79]
    ds_read_b64_tr_b16 v[232:233], v10 offset:6272
    ds_read_b64_tr_b16 v[234:235], v10 offset:7040
    v_mul_f32 v113, v121, v113
    v_mul_f32 v114, v122, v114
    v_mul_f32 v115, v123, v115
    v_mul_f32 v116, v124, v116
    v_mul_f32 v117, v125, v117
    s_waitcnt lgkmcnt(12)
    v_mfma_f32_32x32x16_bf16 v[80:95], v[208:211], v[128:131], v[80:95]
    ds_read_b64_tr_b16 v[236:237], v10 offset:9344
    ds_read_b64_tr_b16 v[238:239], v10 offset:10112
    v_mul_f32 v118, v126, v118
    v_mul_f32 v119, v127, v119
    v_cvt_pk_bf16_f32 v32, v112, v113
    v_cvt_pk_bf16_f32 v33, v114, v115
    v_cvt_pk_bf16_f32 v34, v116, v117
    s_waitcnt lgkmcnt(12)
    v_mfma_f32_32x32x16_bf16 v[80:95], v[212:215], v[132:135], v[80:95]
    ds_read_b64_tr_b16 v[208:209], v11 offset:128
    ds_read_b64_tr_b16 v[210:211], v11 offset:896
    v_cvt_pk_bf16_f32 v35, v118, v119
    buffer_store_dwordx4 v[32:35], v2, s[64:67], s14 offen offset:1024 sc1
    v_cvt_pk_bf16_f32 v240, 0, v48
    v_cvt_pk_bf16_f32 v241, 0, v49
    v_cvt_pk_bf16_f32 v242, 0, v50
    s_waitcnt lgkmcnt(12)
    v_mfma_f32_32x32x16_bf16 v[80:95], v[216:219], v[136:139], v[80:95]
    ds_read_b64_tr_b16 v[212:213], v11 offset:3200
    ds_read_b64_tr_b16 v[214:215], v11 offset:3968
    v_cvt_pk_bf16_f32 v243, 0, v51
    v_cvt_pk_bf16_f32 v244, 0, v52
    v_cvt_pk_bf16_f32 v245, 0, v53
    v_cvt_pk_bf16_f32 v246, 0, v54
    v_cvt_pk_bf16_f32 v247, 0, v55
    s_waitcnt lgkmcnt(12)
    v_mfma_f32_32x32x16_bf16 v[80:95], v[220:223], v[140:143], v[80:95]
    ds_read_b64_tr_b16 v[216:217], v11 offset:6272
    ds_read_b64_tr_b16 v[218:219], v11 offset:7040
    v_mul_f32 v248, s12, v240
    v_mul_f32 v249, s12, v241
    v_mul_f32 v250, s12, v242
    v_mul_f32 v251, s12, v243
    v_mul_f32 v252, s12, v244
    s_waitcnt lgkmcnt(12)
    v_mfma_f32_32x32x16_bf16 v[80:95], v[224:227], v[144:147], v[80:95]
    ds_read_b64_tr_b16 v[220:221], v11 offset:9344
    ds_read_b64_tr_b16 v[222:223], v11 offset:10112
    v_mul_f32 v253, s12, v245
    v_mul_f32 v254, s12, v246
    v_mul_f32 v255, s12, v247
    v_exp_f32 v248, v248
    s_waitcnt lgkmcnt(12)
    v_mfma_f32_32x32x16_bf16 v[80:95], v[228:231], v[148:151], v[80:95]
    ds_read_b64_tr_b16 v[224:225], v9 offset:160
    ds_read_b64_tr_b16 v[226:227], v9 offset:928
    v_exp_f32 v249, v249
    v_exp_f32 v250, v250
    v_exp_f32 v251, v251
    s_waitcnt lgkmcnt(12)
    v_mfma_f32_32x32x16_bf16 v[80:95], v[232:235], v[152:155], v[80:95]
    ds_read_b64_tr_b16 v[228:229], v9 offset:3232
    ds_read_b64_tr_b16 v[230:231], v9 offset:4000
    v_exp_f32 v252, v252
    v_exp_f32 v253, v253
    v_exp_f32 v254, v254
    s_waitcnt lgkmcnt(12)
    v_mfma_f32_32x32x16_bf16 v[80:95], v[236:239], v[156:159], v[80:95]
    ds_read_b64_tr_b16 v[232:233], v9 offset:6304
    ds_read_b64_tr_b16 v[234:235], v9 offset:7072
    v_exp_f32 v255, v255
    v_add_f32 v248, 1.0, v248
    v_add_f32 v249, 1.0, v249
    v_add_f32 v250, 1.0, v250
    s_waitcnt lgkmcnt(12)
    v_mfma_f32_32x32x16_bf16 v[80:95], v[208:211], v[160:163], v[80:95]
    ds_read_b64_tr_b16 v[236:237], v9 offset:9376
    ds_read_b64_tr_b16 v[238:239], v9 offset:10144
    v_add_f32 v251, 1.0, v251
    v_add_f32 v252, 1.0, v252
    v_add_f32 v253, 1.0, v253
    v_add_f32 v254, 1.0, v254
    v_add_f32 v255, 1.0, v255
    s_waitcnt lgkmcnt(12)
    v_mfma_f32_32x32x16_bf16 v[80:95], v[212:215], v[164:167], v[80:95]
    ds_read_b64_tr_b16 v[208:209], v10 offset:160
    ds_read_b64_tr_b16 v[210:211], v10 offset:928
    v_rcp_f32 v248, v248
    v_rcp_f32 v249, v249
    v_rcp_f32 v250, v250
    s_waitcnt lgkmcnt(12)
    v_mfma_f32_32x32x16_bf16 v[80:95], v[216:219], v[168:171], v[80:95]
    ds_read_b64_tr_b16 v[212:213], v10 offset:3232
    ds_read_b64_tr_b16 v[214:215], v10 offset:4000
    v_rcp_f32 v251, v251
    v_rcp_f32 v252, v252
    v_rcp_f32 v253, v253
    s_waitcnt lgkmcnt(12)
    v_mfma_f32_32x32x16_bf16 v[80:95], v[220:223], v[172:175], v[80:95]
    ds_read_b64_tr_b16 v[216:217], v10 offset:6304
    ds_read_b64_tr_b16 v[218:219], v10 offset:7072
    v_rcp_f32 v254, v254
    v_rcp_f32 v255, v255
    v_mul_f32 v240, v248, v240
    s_waitcnt lgkmcnt(12)
    v_mfma_f32_32x32x16_bf16 v[96:111], v[224:227], v[128:131], v[96:111]
    ds_read_b64_tr_b16 v[220:221], v10 offset:9376
    ds_read_b64_tr_b16 v[222:223], v10 offset:10144
    v_mul_f32 v241, v249, v241
    v_mul_f32 v242, v250, v242
    v_mul_f32 v243, v251, v243
    v_mul_f32 v244, v252, v244
    v_mul_f32 v245, v253, v245
    s_waitcnt lgkmcnt(12)
    v_mfma_f32_32x32x16_bf16 v[96:111], v[228:231], v[132:135], v[96:111]
    ds_read_b64_tr_b16 v[224:225], v11 offset:160
    ds_read_b64_tr_b16 v[226:227], v11 offset:928
    v_mul_f32 v246, v254, v246
    v_mul_f32 v247, v255, v247
    v_cvt_pk_bf16_f32 v248, 0, v56
    v_cvt_pk_bf16_f32 v249, 0, v57
    v_cvt_pk_bf16_f32 v250, 0, v58
    s_waitcnt lgkmcnt(12)
    v_mfma_f32_32x32x16_bf16 v[96:111], v[232:235], v[136:139], v[96:111]
    ds_read_b64_tr_b16 v[228:229], v11 offset:3232
    ds_read_b64_tr_b16 v[230:231], v11 offset:4000
    v_cvt_pk_bf16_f32 v251, 0, v59
    v_cvt_pk_bf16_f32 v252, 0, v60
    v_cvt_pk_bf16_f32 v253, 0, v61
    v_cvt_pk_bf16_f32 v254, 0, v62
    v_cvt_pk_bf16_f32 v255, 0, v63
    s_waitcnt lgkmcnt(12)
    v_mfma_f32_32x32x16_bf16 v[96:111], v[236:239], v[140:143], v[96:111]
    ds_read_b64_tr_b16 v[232:233], v11 offset:6304
    ds_read_b64_tr_b16 v[234:235], v11 offset:7072
    v_cvt_pk_bf16_f32 v240, 0, v240
    v_cvt_pk_bf16_f32 v241, 0, v241
    v_cvt_pk_bf16_f32 v242, 0, v242
    v_cvt_pk_bf16_f32 v243, 0, v243
    v_cvt_pk_bf16_f32 v244, 0, v244
    s_waitcnt lgkmcnt(12)
    v_mfma_f32_32x32x16_bf16 v[96:111], v[208:211], v[144:147], v[96:111]
    ds_read_b64_tr_b16 v[236:237], v11 offset:9376
    ds_read_b64_tr_b16 v[238:239], v11 offset:10144
    v_cvt_pk_bf16_f32 v245, 0, v245
    v_cvt_pk_bf16_f32 v246, 0, v246
    v_cvt_pk_bf16_f32 v247, 0, v247
    v_mul_f32 v240, v248, v240
    v_mul_f32 v241, v249, v241
    s_waitcnt lgkmcnt(12)
    v_mfma_f32_32x32x16_bf16 v[96:111], v[212:215], v[148:151], v[96:111]
    v_mul_f32 v242, v250, v242
    v_mul_f32 v243, v251, v243
    v_mul_f32 v244, v252, v244
    v_mul_f32 v245, v253, v245
    v_mul_f32 v246, v254, v246
    v_mul_f32 v247, v255, v247
    v_cvt_pk_bf16_f32 v48, v240, v241
    s_waitcnt lgkmcnt(0)
    s_barrier
    v_mfma_f32_32x32x16_bf16 v[96:111], v[216:219], v[152:155], v[96:111]
    v_cvt_pk_bf16_f32 v49, v242, v243
    v_cvt_pk_bf16_f32 v50, v244, v245
    v_cvt_pk_bf16_f32 v51, v246, v247
    buffer_store_dwordx4 v[48:51], v2, s[64:67], s14 offen offset:2048 sc1
    v_cvt_pk_bf16_f32 v112, 0, v64
    v_cvt_pk_bf16_f32 v113, 0, v65
    v_cvt_pk_bf16_f32 v114, 0, v66
    s_waitcnt lgkmcnt(8)
    v_mfma_f32_32x32x16_bf16 v[96:111], v[220:223], v[156:159], v[96:111]
    v_cvt_pk_bf16_f32 v115, 0, v67
    v_cvt_pk_bf16_f32 v116, 0, v68
    v_cvt_pk_bf16_f32 v117, 0, v69
    v_cvt_pk_bf16_f32 v118, 0, v70
    v_cvt_pk_bf16_f32 v119, 0, v71
    v_mul_f32 v120, s12, v112
    v_mul_f32 v121, s12, v113
    s_waitcnt lgkmcnt(6)
    v_mfma_f32_32x32x16_bf16 v[96:111], v[224:227], v[160:163], v[96:111]
    v_mul_f32 v122, s12, v114
    v_mul_f32 v123, s12, v115
    v_mul_f32 v124, s12, v116
    v_mul_f32 v125, s12, v117
    v_mul_f32 v126, s12, v118
    v_mul_f32 v127, s12, v119
    v_exp_f32 v120, v120
    s_waitcnt lgkmcnt(4)
    v_mfma_f32_32x32x16_bf16 v[96:111], v[228:231], v[164:167], v[96:111]
    v_exp_f32 v121, v121
    v_exp_f32 v122, v122
    v_exp_f32 v123, v123
    v_exp_f32 v124, v124
    s_waitcnt lgkmcnt(2)
    v_mfma_f32_32x32x16_bf16 v[96:111], v[232:235], v[168:171], v[96:111]
    v_exp_f32 v125, v125
    v_exp_f32 v126, v126
    v_exp_f32 v127, v127
    v_add_f32 v120, 1.0, v120
    s_waitcnt lgkmcnt(0)
    v_mfma_f32_32x32x16_bf16 v[96:111], v[236:239], v[172:175], v[96:111]
    v_add_f32 v121, 1.0, v121
    v_add_f32 v122, 1.0, v122
    v_add_f32 v123, 1.0, v123
    v_add_f32 v124, 1.0, v124
    v_add_f32 v125, 1.0, v125
    v_add_f32 v126, 1.0, v126
    v_add_f32 v127, 1.0, v127
    v_rcp_f32 v120, v120
    v_rcp_f32 v121, v121
    v_rcp_f32 v122, v122
    v_rcp_f32 v123, v123
    v_rcp_f32 v124, v124
    v_rcp_f32 v125, v125
    v_rcp_f32 v126, v126
    v_rcp_f32 v127, v127
    v_mul_f32 v112, v120, v112
    v_mul_f32 v113, v121, v113
    v_mul_f32 v114, v122, v114
    v_mul_f32 v115, v123, v115
    v_mul_f32 v116, v124, v116
    v_mul_f32 v117, v125, v117
    v_mul_f32 v118, v126, v118
    v_mul_f32 v119, v127, v119
    v_cvt_pk_bf16_f32 v120, 0, v72
    v_cvt_pk_bf16_f32 v121, 0, v73
    v_cvt_pk_bf16_f32 v122, 0, v74
    v_cvt_pk_bf16_f32 v123, 0, v75
    v_cvt_pk_bf16_f32 v124, 0, v76
    v_cvt_pk_bf16_f32 v125, 0, v77
    v_cvt_pk_bf16_f32 v126, 0, v78
    v_cvt_pk_bf16_f32 v127, 0, v79
    v_cvt_pk_bf16_f32 v112, 0, v112
    v_cvt_pk_bf16_f32 v113, 0, v113
    v_cvt_pk_bf16_f32 v114, 0, v114
    v_cvt_pk_bf16_f32 v115, 0, v115
    v_cvt_pk_bf16_f32 v116, 0, v116
    v_cvt_pk_bf16_f32 v117, 0, v117
    v_cvt_pk_bf16_f32 v118, 0, v118
    v_cvt_pk_bf16_f32 v119, 0, v119
    v_mul_f32 v112, v120, v112
    v_mul_f32 v113, v121, v113
    v_mul_f32 v114, v122, v114
    v_mul_f32 v115, v123, v115
    v_mul_f32 v116, v124, v116
    v_mul_f32 v117, v125, v117
    v_mul_f32 v118, v126, v118
    v_mul_f32 v119, v127, v119
    v_cvt_pk_bf16_f32 v64, v112, v113
    v_cvt_pk_bf16_f32 v65, v114, v115
    v_cvt_pk_bf16_f32 v66, v116, v117
    v_cvt_pk_bf16_f32 v67, v118, v119
    buffer_store_dwordx4 v[64:67], v2, s[64:67], s14 offen offset:3072 sc1
    v_cvt_pk_bf16_f32 v240, 0, v80
    v_cvt_pk_bf16_f32 v241, 0, v81
    v_cvt_pk_bf16_f32 v242, 0, v82
    v_cvt_pk_bf16_f32 v243, 0, v83
    v_cvt_pk_bf16_f32 v244, 0, v84
    v_cvt_pk_bf16_f32 v245, 0, v85
    v_cvt_pk_bf16_f32 v246, 0, v86
    v_cvt_pk_bf16_f32 v247, 0, v87
    v_pk_mul_f32 v[248:249], v[240:241], s[12:13]
    v_pk_mul_f32 v[250:251], v[242:243], s[12:13]
    v_pk_mul_f32 v[252:253], v[244:245], s[12:13]
    v_pk_mul_f32 v[254:255], v[246:247], s[12:13]
    v_exp_f32 v248, v248
    v_exp_f32 v249, v249
    v_exp_f32 v250, v250
    v_exp_f32 v251, v251
    v_exp_f32 v252, v252
    v_exp_f32 v253, v253
    v_exp_f32 v254, v254
    v_exp_f32 v255, v255
    v_pk_add_f32 v[248:249], v[248:249], 1.0 op_sel_hi:[1,0]
    v_pk_add_f32 v[250:251], v[250:251], 1.0 op_sel_hi:[1,0]
    v_pk_add_f32 v[252:253], v[252:253], 1.0 op_sel_hi:[1,0]
    v_pk_add_f32 v[254:255], v[254:255], 1.0 op_sel_hi:[1,0]
    v_rcp_f32 v248, v248
    v_rcp_f32 v249, v249
    v_rcp_f32 v250, v250
    v_rcp_f32 v251, v251
    v_rcp_f32 v252, v252
    v_rcp_f32 v253, v253
    v_rcp_f32 v254, v254
    v_rcp_f32 v255, v255
    v_pk_mul_f32 v[240:241], v[240:241], v[248:249]
    v_pk_mul_f32 v[242:243], v[242:243], v[250:251]
    v_pk_mul_f32 v[244:245], v[244:245], v[252:253]
    v_pk_mul_f32 v[246:247], v[246:247], v[254:255]
    v_cvt_pk_bf16_f32 v248, 0, v88
    v_cvt_pk_bf16_f32 v249, 0, v89
    v_cvt_pk_bf16_f32 v250, 0, v90
    v_cvt_pk_bf16_f32 v251, 0, v91
    v_cvt_pk_bf16_f32 v252, 0, v92
    v_cvt_pk_bf16_f32 v253, 0, v93
    v_cvt_pk_bf16_f32 v254, 0, v94
    v_cvt_pk_bf16_f32 v255, 0, v95
    v_cvt_pk_bf16_f32 v240, 0, v240
    v_cvt_pk_bf16_f32 v241, 0, v241
    v_cvt_pk_bf16_f32 v242, 0, v242
    v_cvt_pk_bf16_f32 v243, 0, v243
    v_cvt_pk_bf16_f32 v244, 0, v244
    v_cvt_pk_bf16_f32 v245, 0, v245
    v_cvt_pk_bf16_f32 v246, 0, v246
    v_cvt_pk_bf16_f32 v247, 0, v247
    v_pk_mul_f32 v[240:241], v[240:241], v[248:249]
    v_pk_mul_f32 v[242:243], v[242:243], v[250:251]
    v_pk_mul_f32 v[244:245], v[244:245], v[252:253]
    v_pk_mul_f32 v[246:247], v[246:247], v[254:255]
    v_cvt_pk_bf16_f32 v80, v240, v241
    v_cvt_pk_bf16_f32 v81, v242, v243
    v_cvt_pk_bf16_f32 v82, v244, v245
    v_cvt_pk_bf16_f32 v83, v246, v247
    buffer_store_dwordx4 v[80:83], v2, s[64:67], s15 offen offset:0 sc1
    v_cvt_pk_bf16_f32 v112, 0, v96
    v_cvt_pk_bf16_f32 v113, 0, v97
    v_cvt_pk_bf16_f32 v114, 0, v98
    v_cvt_pk_bf16_f32 v115, 0, v99
    v_cvt_pk_bf16_f32 v116, 0, v100
    v_cvt_pk_bf16_f32 v117, 0, v101
    v_cvt_pk_bf16_f32 v118, 0, v102
    v_cvt_pk_bf16_f32 v119, 0, v103
    v_pk_mul_f32 v[120:121], v[112:113], s[12:13]
    v_pk_mul_f32 v[122:123], v[114:115], s[12:13]
    v_pk_mul_f32 v[124:125], v[116:117], s[12:13]
    v_pk_mul_f32 v[126:127], v[118:119], s[12:13]
    v_exp_f32 v120, v120
    v_exp_f32 v121, v121
    v_exp_f32 v122, v122
    v_exp_f32 v123, v123
    v_exp_f32 v124, v124
    v_exp_f32 v125, v125
    v_exp_f32 v126, v126
    v_exp_f32 v127, v127
    v_pk_add_f32 v[120:121], v[120:121], 1.0 op_sel_hi:[1,0]
    v_pk_add_f32 v[122:123], v[122:123], 1.0 op_sel_hi:[1,0]
    v_pk_add_f32 v[124:125], v[124:125], 1.0 op_sel_hi:[1,0]
    v_pk_add_f32 v[126:127], v[126:127], 1.0 op_sel_hi:[1,0]
    v_rcp_f32 v120, v120
    v_rcp_f32 v121, v121
    v_rcp_f32 v122, v122
    v_rcp_f32 v123, v123
    v_rcp_f32 v124, v124
    v_rcp_f32 v125, v125
    v_rcp_f32 v126, v126
    v_rcp_f32 v127, v127
    v_pk_mul_f32 v[112:113], v[112:113], v[120:121]
    v_pk_mul_f32 v[114:115], v[114:115], v[122:123]
    v_pk_mul_f32 v[116:117], v[116:117], v[124:125]
    v_pk_mul_f32 v[118:119], v[118:119], v[126:127]
    v_cvt_pk_bf16_f32 v120, 0, v104
    v_cvt_pk_bf16_f32 v121, 0, v105
    v_cvt_pk_bf16_f32 v122, 0, v106
    v_cvt_pk_bf16_f32 v123, 0, v107
    v_cvt_pk_bf16_f32 v124, 0, v108
    v_cvt_pk_bf16_f32 v125, 0, v109
    v_cvt_pk_bf16_f32 v126, 0, v110
    v_cvt_pk_bf16_f32 v127, 0, v111
    v_cvt_pk_bf16_f32 v112, 0, v112
    v_cvt_pk_bf16_f32 v113, 0, v113
    v_cvt_pk_bf16_f32 v114, 0, v114
    v_cvt_pk_bf16_f32 v115, 0, v115
    v_cvt_pk_bf16_f32 v116, 0, v116
    v_cvt_pk_bf16_f32 v117, 0, v117
    v_cvt_pk_bf16_f32 v118, 0, v118
    v_cvt_pk_bf16_f32 v119, 0, v119
    v_pk_mul_f32 v[112:113], v[112:113], v[120:121]
    v_pk_mul_f32 v[114:115], v[114:115], v[122:123]
    v_pk_mul_f32 v[116:117], v[116:117], v[124:125]
    v_pk_mul_f32 v[118:119], v[118:119], v[126:127]
    v_cvt_pk_bf16_f32 v96, v112, v113
    v_cvt_pk_bf16_f32 v97, v114, v115
    v_cvt_pk_bf16_f32 v98, v116, v117
    v_cvt_pk_bf16_f32 v99, v118, v119
    buffer_store_dwordx4 v[96:99], v2, s[64:67], s15 offen offset:1024 sc1
    s_lshl_b32 s6, s4, 4
    s_add_u32 s6, s6, s49
    s_lshl_b32 s6, s6, 3
    s_add_u32 s6, s6, 19922944
    v_mov_b32 v6, 0
    v_mov_b32 v8, s86
    v_mov_b32 v9, s87
    s_waitcnt vmcnt(0)
    s_mov_b64 exec, 1
    buffer_store_dwordx2 v[8:9], v6, s[64:67], s6 offen sc1
    s_mov_b64 exec, -1
    s_branch M_SEAM
M_15:
    s_mov_b32 s8, s40
    s_and_b32 s9, s41, 0xffff
    s_mov_b32 s10, 0x158000
    s_mov_b32 s11, 0x20000
    s_mul_i32 s92, s3, 22
    s_cmp_eq_u32 s3, 3
    s_cselect_b32 s92, 65, s92
    v_lshrrev_b32 v6, 3, v0
    v_and_b32 v7, 7, v0
    v_lshrrev_b32 v5, 2, v0
    v_and_b32 v5, 4, v5
    v_xor_b32 v7, v7, v5
    v_lshlrev_b32 v5, 10, v6
    v_lshl_add_u32 v5, v7, 4, v5
    s_lshl_b32 s93, s92, 14
    s_lshl_b32 s94, s52, 7
    s_add_u32 s93, s93, s94
    s_lshl_b32 s94, s3, 11
    s_add_u32 s94, s94, 73920
    s_barrier
M_SEAM:
    s_setprio 0
    s_add_u32 s7, s93, 163840
    buffer_load_dwordx4 v[128:131], v5, s[8:11], s7 offen
    s_add_u32 s7, s93, 172032
    buffer_load_dwordx4 v[132:135], v5, s[8:11], s7 offen
    s_add_u32 s7, s93, 180224
    buffer_load_dwordx4 v[136:139], v5, s[8:11], s7 offen
    s_add_u32 s7, s93, 188416
    buffer_load_dwordx4 v[140:143], v5, s[8:11], s7 offen
    s_add_u32 s7, s93, 196608
    buffer_load_dwordx4 v[144:147], v5, s[8:11], s7 offen
    s_add_u32 s7, s93, 204800
    buffer_load_dwordx4 v[148:151], v5, s[8:11], s7 offen
    s_add_u32 s7, s93, 212992
    buffer_load_dwordx4 v[152:155], v5, s[8:11], s7 offen
    s_add_u32 s7, s93, 221184
    buffer_load_dwordx4 v[156:159], v5, s[8:11], s7 offen
    s_add_u32 s7, s93, 229376
    buffer_load_dwordx4 v[160:163], v5, s[8:11], s7 offen
    s_add_u32 s7, s93, 237568
    buffer_load_dwordx4 v[164:167], v5, s[8:11], s7 offen
    s_add_u32 s7, s93, 245760
    buffer_load_dwordx4 v[168:171], v5, s[8:11], s7 offen
    s_add_u32 s7, s93, 253952
    buffer_load_dwordx4 v[172:175], v5, s[8:11], s7 offen
    s_add_u32 s7, s93, 262144
    buffer_load_dwordx4 v[176:179], v5, s[8:11], s7 offen
    s_add_u32 s7, s93, 270336
    buffer_load_dwordx4 v[180:183], v5, s[8:11], s7 offen
    s_add_u32 s7, s93, 278528
    buffer_load_dwordx4 v[184:187], v5, s[8:11], s7 offen
    s_add_u32 s7, s93, 286720
    buffer_load_dwordx4 v[188:191], v5, s[8:11], s7 offen
    s_add_u32 s7, s93, 294912
    buffer_load_dwordx4 v[192:195], v5, s[8:11], s7 offen
    s_add_u32 s7, s93, 303104
    buffer_load_dwordx4 v[196:199], v5, s[8:11], s7 offen
    s_add_u32 s7, s93, 311296
    buffer_load_dwordx4 v[200:203], v5, s[8:11], s7 offen
    s_add_u32 s7, s93, 319488
    buffer_load_dwordx4 v[204:207], v5, s[8:11], s7 offen
    s_add_u32 s7, s93, 327680
    buffer_load_dwordx4 v[208:211], v5, s[8:11], s7 offen
    s_add_u32 s7, s93, 335872
    buffer_load_dwordx4 v[212:215], v5, s[8:11], s7 offen
    s_add_u32 s7, s93, 344064
    buffer_load_dwordx4 v[216:219], v5, s[8:11], s7 offen
    s_add_u32 s7, s93, 352256
    buffer_load_dwordx4 v[220:223], v5, s[8:11], s7 offen
    s_mov_b32 s60, s42
    s_and_b32 s61, s43, 0xffff
    s_mov_b32 s62, 0x200000
    s_mov_b32 s63, 0x20000
    s_mul_i32 s82, s51, 172
    s_add_u32 s82, s82, s92
    s_lshl_b32 s82, s82, 10
    v_add_u32 v3, 88064, v2
    v_add_u32 v4, s94, v2
    v_add_u32 v13, 40960, v4
    v_lshrrev_b32 v6, 5, v0
    v_bfe_u32 v7, v0, 2, 2
    v_lshl_add_u32 v7, v6, 2, v7
    v_lshlrev_b32 v7, 7, v7
    v_bfe_u32 v8, v0, 4, 1
    v_lshl_add_u32 v7, v8, 5, v7
    v_and_b32 v8, 3, v0
    v_lshl_add_u32 v7, v8, 3, v7
    v_add_u32 v7, s94, v7
    v_bfe_u32 v9, v0, 3, 1
    v_lshl_add_u32 v8, v9, 6, v7
    v_xor_b32 v9, 1, v9
    v_lshl_add_u32 v9, v9, 6, v7
    v_add_u32 v10, 40960, v8
    v_add_u32 v11, 40960, v9
    v_mov_b32 v12, 155840
    s_lshl_b32 s83, s51, 8
    s_add_u32 s83, s83, 19922944
    v_and_b32 v14, 31, v0
    v_lshlrev_b32 v14, 3, v14
    s_mov_b32 s95, 0
    s_mov_b32 s96, 0x7fff7fff
    s_mov_b32 s97, 0x7fff7fff
    s_cmp_lg_u32 s3, 0
    s_cbranch_scc1 M_HWAIT
M_HPOLL:
    buffer_load_dwordx2 v[240:241], v14, s[64:67], s83 offen sc1
    s_add_u32 s95, s95, 1
    s_waitcnt vmcnt(0)
    v_xor_b32 v240, s86, v240
    v_xor_b32 v241, s87, v241
    v_or_b32 v15, v240, v241
    v_cmp_ne_u32 vcc, 0, v15
    s_and_b64 vcc, vcc, s[96:97]
    s_cbranch_vccz M_HOK
    s_cmp_ge_u32 s95, 0x4000
    s_cbranch_scc1 M_HOK
    s_sleep 3
    s_branch M_HPOLL
M_HOK:
    v_mov_b32 v15, 1
    ds_write_b32 v12, v15 offset:12
    s_branch M_HGO
M_HWAIT:
SPIN_14:
    ds_read_b32 v15, v12 offset:12
    s_waitcnt lgkmcnt(0)
    v_readfirstlane_b32 s95, v15
    s_cmp_ge_u32 s95, 1
    s_cbranch_scc0 SPIN_14
M_HGO:
    buffer_load_dwordx4 v[80:83], v2, s[64:67], s82 offen offset:0 sc1
    buffer_load_dwordx4 v[84:87], v3, s[64:67], s82 offen offset:0 sc1
    buffer_load_dwordx4 v[88:91], v2, s[64:67], s82 offen offset:1024 sc1
    buffer_load_dwordx4 v[92:95], v3, s[64:67], s82 offen offset:1024 sc1
    buffer_load_dwordx4 v[96:99], v2, s[64:67], s82 offen offset:2048 sc1
    buffer_load_dwordx4 v[100:103], v3, s[64:67], s82 offen offset:2048 sc1
    buffer_load_dwordx4 v[104:107], v2, s[64:67], s82 offen offset:3072 sc1
    buffer_load_dwordx4 v[108:111], v3, s[64:67], s82 offen offset:3072 sc1
    s_add_u32 s82, s82, 4096
    buffer_load_dwordx4 v[112:115], v2, s[64:67], s82 offen offset:0 sc1
    buffer_load_dwordx4 v[116:119], v3, s[64:67], s82 offen offset:0 sc1
    buffer_load_dwordx4 v[120:123], v2, s[64:67], s82 offen offset:1024 sc1
    buffer_load_dwordx4 v[124:127], v3, s[64:67], s82 offen offset:1024 sc1
    ds_read_b64_tr_b16 v[224:225], v8 offset:0
    ds_read_b64_tr_b16 v[226:227], v8 offset:1024
    ds_read_b64_tr_b16 v[228:229], v9 offset:0
    ds_read_b64_tr_b16 v[230:231], v9 offset:1024
    s_waitcnt vmcnt(10) lgkmcnt(0)
    v_mfma_f32_32x32x16_bf16 v[16:31], v[224:227], v[80:83], 0
    ds_read_b64_tr_b16 v[232:233], v8 offset:8192
    ds_read_b64_tr_b16 v[234:235], v8 offset:9216
    v_mfma_f32_32x32x16_bf16 v[32:47], v[224:227], v[84:87], 0
    ds_read_b64_tr_b16 v[236:237], v9 offset:8192
    ds_read_b64_tr_b16 v[238:239], v9 offset:9216
    v_mfma_f32_32x32x16_bf16 v[48:63], v[228:231], v[80:83], 0
    v_mfma_f32_32x32x16_bf16 v[64:79], v[228:231], v[84:87], 0
    ds_write_b128 v4, v[128:131] offset:0
    ds_write_b128 v4, v[132:135] offset:1024
    buffer_load_dwordx4 v[80:83], v2, s[64:67], s82 offen offset:2048 sc1
    buffer_load_dwordx4 v[84:87], v3, s[64:67], s82 offen offset:2048 sc1
    s_waitcnt vmcnt(10) lgkmcnt(2)
    v_mfma_f32_32x32x16_bf16 v[16:31], v[232:235], v[88:91], v[16:31]
    ds_read_b64_tr_b16 v[224:225], v8 offset:16384
    ds_read_b64_tr_b16 v[226:227], v8 offset:17408
    v_mfma_f32_32x32x16_bf16 v[32:47], v[232:235], v[92:95], v[32:47]
    ds_read_b64_tr_b16 v[228:229], v9 offset:16384
    ds_read_b64_tr_b16 v[230:231], v9 offset:17408
    v_mfma_f32_32x32x16_bf16 v[48:63], v[236:239], v[88:91], v[48:63]
    v_mfma_f32_32x32x16_bf16 v[64:79], v[236:239], v[92:95], v[64:79]
    ds_write_b128 v4, v[136:139] offset:8192
    ds_write_b128 v4, v[140:143] offset:9216
    buffer_load_dwordx4 v[88:91], v2, s[64:67], s82 offen offset:3072 sc1
    buffer_load_dwordx4 v[92:95], v3, s[64:67], s82 offen offset:3072 sc1
    s_waitcnt vmcnt(10) lgkmcnt(2)
    v_mfma_f32_32x32x16_bf16 v[16:31], v[224:227], v[96:99], v[16:31]
    ds_read_b64_tr_b16 v[232:233], v8 offset:24576
    ds_read_b64_tr_b16 v[234:235], v8 offset:25600
    v_mfma_f32_32x32x16_bf16 v[32:47], v[224:227], v[100:103], v[32:47]
    ds_read_b64_tr_b16 v[236:237], v9 offset:24576
    ds_read_b64_tr_b16 v[238:239], v9 offset:25600
    v_mfma_f32_32x32x16_bf16 v[48:63], v[228:231], v[96:99], v[48:63]
    v_mfma_f32_32x32x16_bf16 v[64:79], v[228:231], v[100:103], v[64:79]
    ds_write_b128 v4, v[144:147] offset:16384
    ds_write_b128 v4, v[148:151] offset:17408
    s_add_u32 s82, s82, 4096
    buffer_load_dwordx4 v[96:99], v2, s[64:67], s82 offen offset:0 sc1
    buffer_load_dwordx4 v[100:103], v3, s[64:67], s82 offen offset:0 sc1
    s_waitcnt vmcnt(10) lgkmcnt(2)
    v_mfma_f32_32x32x16_bf16 v[16:31], v[232:235], v[104:107], v[16:31]
    ds_read_b64_tr_b16 v[224:225], v8 offset:32768
    ds_read_b64_tr_b16 v[226:227], v8 offset:33792
    v_mfma_f32_32x32x16_bf16 v[32:47], v[232:235], v[108:111], v[32:47]
    ds_read_b64_tr_b16 v[228:229], v9 offset:32768
    ds_read_b64_tr_b16 v[230:231], v9 offset:33792
    v_mfma_f32_32x32x16_bf16 v[48:63], v[236:239], v[104:107], v[48:63]
    v_mfma_f32_32x32x16_bf16 v[64:79], v[236:239], v[108:111], v[64:79]
    ds_write_b128 v4, v[152:155] offset:24576
    ds_write_b128 v4, v[156:159] offset:25600
    buffer_load_dwordx4 v[104:107], v2, s[64:67], s82 offen offset:1024 sc1
    buffer_load_dwordx4 v[108:111], v3, s[64:67], s82 offen offset:1024 sc1
    s_waitcnt vmcnt(10) lgkmcnt(2)
    v_mfma_f32_32x32x16_bf16 v[16:31], v[224:227], v[112:115], v[16:31]
    ds_read_b64_tr_b16 v[232:233], v10 offset:0
    ds_read_b64_tr_b16 v[234:235], v10 offset:1024
    v_mfma_f32_32x32x16_bf16 v[32:47], v[224:227], v[116:119], v[32:47]
    ds_read_b64_tr_b16 v[236:237], v11 offset:0
    ds_read_b64_tr_b16 v[238:239], v11 offset:1024
    v_mfma_f32_32x32x16_bf16 v[48:63], v[228:231], v[112:115], v[48:63]
    v_mfma_f32_32x32x16_bf16 v[64:79], v[228:231], v[116:119], v[64:79]
    ds_write_b128 v4, v[160:163] offset:32768
    ds_write_b128 v4, v[164:167] offset:33792
    buffer_load_dwordx4 v[112:115], v2, s[64:67], s82 offen offset:2048 sc1
    buffer_load_dwordx4 v[116:119], v3, s[64:67], s82 offen offset:2048 sc1
    s_waitcnt vmcnt(10) lgkmcnt(2)
    v_mfma_f32_32x32x16_bf16 v[16:31], v[232:235], v[120:123], v[16:31]
    ds_read_b64_tr_b16 v[224:225], v10 offset:8192
    ds_read_b64_tr_b16 v[226:227], v10 offset:9216
    v_mfma_f32_32x32x16_bf16 v[32:47], v[232:235], v[124:127], v[32:47]
    ds_read_b64_tr_b16 v[228:229], v11 offset:8192
    ds_read_b64_tr_b16 v[230:231], v11 offset:9216
    v_mfma_f32_32x32x16_bf16 v[48:63], v[236:239], v[120:123], v[48:63]
    v_mfma_f32_32x32x16_bf16 v[64:79], v[236:239], v[124:127], v[64:79]
    ds_write_b128 v13, v[168:171] offset:0
    ds_write_b128 v13, v[172:175] offset:1024
    buffer_load_dwordx4 v[120:123], v2, s[64:67], s82 offen offset:3072 sc1
    buffer_load_dwordx4 v[124:127], v3, s[64:67], s82 offen offset:3072 sc1
    s_waitcnt vmcnt(10) lgkmcnt(2)
    v_mfma_f32_32x32x16_bf16 v[16:31], v[224:227], v[80:83], v[16:31]
    ds_read_b64_tr_b16 v[232:233], v10 offset:16384
    ds_read_b64_tr_b16 v[234:235], v10 offset:17408
    v_mfma_f32_32x32x16_bf16 v[32:47], v[224:227], v[84:87], v[32:47]
    ds_read_b64_tr_b16 v[236:237], v11 offset:16384
    ds_read_b64_tr_b16 v[238:239], v11 offset:17408
    v_mfma_f32_32x32x16_bf16 v[48:63], v[228:231], v[80:83], v[48:63]
    v_mfma_f32_32x32x16_bf16 v[64:79], v[228:231], v[84:87], v[64:79]
    ds_write_b128 v13, v[176:179] offset:8192
    ds_write_b128 v13, v[180:183] offset:9216
    s_add_u32 s82, s82, 4096
    buffer_load_dwordx4 v[80:83], v2, s[64:67], s82 offen offset:0 sc1
    buffer_load_dwordx4 v[84:87], v3, s[64:67], s82 offen offset:0 sc1
    s_waitcnt vmcnt(10) lgkmcnt(2)
    v_mfma_f32_32x32x16_bf16 v[16:31], v[232:235], v[88:91], v[16:31]
    ds_read_b64_tr_b16 v[224:225], v10 offset:24576
    ds_read_b64_tr_b16 v[226:227], v10 offset:25600
    v_mfma_f32_32x32x16_bf16 v[32:47], v[232:235], v[92:95], v[32:47]
    ds_read_b64_tr_b16 v[228:229], v11 offset:24576
    ds_read_b64_tr_b16 v[230:231], v11 offset:25600
    v_mfma_f32_32x32x16_bf16 v[48:63], v[236:239], v[88:91], v[48:63]
    v_mfma_f32_32x32x16_bf16 v[64:79], v[236:239], v[92:95], v[64:79]
    ds_write_b128 v13, v[184:187] offset:16384
    ds_write_b128 v13, v[188:191] offset:17408
    buffer_load_dwordx4 v[88:91], v2, s[64:67], s82 offen offset:1024 sc1
    buffer_load_dwordx4 v[92:95], v3, s[64:67], s82 offen offset:1024 sc1
    s_waitcnt vmcnt(10) lgkmcnt(2)
    v_mfma_f32_32x32x16_bf16 v[16:31], v[224:227], v[96:99], v[16:31]
    ds_read_b64_tr_b16 v[232:233], v10 offset:32768
    ds_read_b64_tr_b16 v[234:235], v10 offset:33792
    v_mfma_f32_32x32x16_bf16 v[32:47], v[224:227], v[100:103], v[32:47]
    ds_read_b64_tr_b16 v[236:237], v11 offset:32768
    ds_read_b64_tr_b16 v[238:239], v11 offset:33792
    v_mfma_f32_32x32x16_bf16 v[48:63], v[228:231], v[96:99], v[48:63]
    v_mfma_f32_32x32x16_bf16 v[64:79], v[228:231], v[100:103], v[64:79]
    ds_write_b128 v13, v[192:195] offset:24576
    ds_write_b128 v13, v[196:199] offset:25600
    buffer_load_dwordx4 v[96:99], v2, s[64:67], s82 offen offset:2048 sc1
    buffer_load_dwordx4 v[100:103], v3, s[64:67], s82 offen offset:2048 sc1
    s_waitcnt vmcnt(10) lgkmcnt(2)
    v_mfma_f32_32x32x16_bf16 v[16:31], v[232:235], v[104:107], v[16:31]
    ds_read_b64_tr_b16 v[224:225], v8 offset:0
    ds_read_b64_tr_b16 v[226:227], v8 offset:1024
    v_mfma_f32_32x32x16_bf16 v[32:47], v[232:235], v[108:111], v[32:47]
    ds_read_b64_tr_b16 v[228:229], v9 offset:0
    ds_read_b64_tr_b16 v[230:231], v9 offset:1024
    v_mfma_f32_32x32x16_bf16 v[48:63], v[236:239], v[104:107], v[48:63]
    v_mfma_f32_32x32x16_bf16 v[64:79], v[236:239], v[108:111], v[64:79]
    ds_write_b128 v13, v[200:203] offset:32768
    ds_write_b128 v13, v[204:207] offset:33792
    buffer_load_dwordx4 v[104:107], v2, s[64:67], s82 offen offset:3072 sc1
    buffer_load_dwordx4 v[108:111], v3, s[64:67], s82 offen offset:3072 sc1
    s_waitcnt vmcnt(10) lgkmcnt(2)
    v_mfma_f32_32x32x16_bf16 v[16:31], v[224:227], v[112:115], v[16:31]
    ds_read_b64_tr_b16 v[232:233], v8 offset:8192
    ds_read_b64_tr_b16 v[234:235], v8 offset:9216
    v_mfma_f32_32x32x16_bf16 v[32:47], v[224:227], v[116:119], v[32:47]
    ds_read_b64_tr_b16 v[236:237], v9 offset:8192
    ds_read_b64_tr_b16 v[238:239], v9 offset:9216
    v_mfma_f32_32x32x16_bf16 v[48:63], v[228:231], v[112:115], v[48:63]
    v_mfma_f32_32x32x16_bf16 v[64:79], v[228:231], v[116:119], v[64:79]
    ds_write_b128 v4, v[208:211] offset:0
    ds_write_b128 v4, v[212:215] offset:1024
    s_add_u32 s82, s82, 4096
    buffer_load_dwordx4 v[112:115], v2, s[64:67], s82 offen offset:0 sc1
    buffer_load_dwordx4 v[116:119], v3, s[64:67], s82 offen offset:0 sc1
    s_waitcnt vmcnt(10) lgkmcnt(2)
    v_mfma_f32_32x32x16_bf16 v[16:31], v[232:235], v[120:123], v[16:31]
    ds_read_b64_tr_b16 v[224:225], v8 offset:16384
    ds_read_b64_tr_b16 v[226:227], v8 offset:17408
    v_mfma_f32_32x32x16_bf16 v[32:47], v[232:235], v[124:127], v[32:47]
    ds_read_b64_tr_b16 v[228:229], v9 offset:16384
    ds_read_b64_tr_b16 v[230:231], v9 offset:17408
    v_mfma_f32_32x32x16_bf16 v[48:63], v[236:239], v[120:123], v[48:63]
    v_mfma_f32_32x32x16_bf16 v[64:79], v[236:239], v[124:127], v[64:79]
    ds_write_b128 v4, v[216:219] offset:8192
    ds_write_b128 v4, v[220:223] offset:9216
    buffer_load_dwordx4 v[120:123], v2, s[64:67], s82 offen offset:1024 sc1
    buffer_load_dwordx4 v[124:127], v3, s[64:67], s82 offen offset:1024 sc1
    s_waitcnt vmcnt(10) lgkmcnt(2)
    v_mfma_f32_32x32x16_bf16 v[16:31], v[224:227], v[80:83], v[16:31]
    ds_read_b64_tr_b16 v[232:233], v8 offset:24576
    ds_read_b64_tr_b16 v[234:235], v8 offset:25600
    v_mfma_f32_32x32x16_bf16 v[32:47], v[224:227], v[84:87], v[32:47]
    ds_read_b64_tr_b16 v[236:237], v9 offset:24576
    ds_read_b64_tr_b16 v[238:239], v9 offset:25600
    v_mfma_f32_32x32x16_bf16 v[48:63], v[228:231], v[80:83], v[48:63]
    v_mfma_f32_32x32x16_bf16 v[64:79], v[228:231], v[84:87], v[64:79]
    buffer_load_dwordx4 v[80:83], v2, s[64:67], s82 offen offset:2048 sc1
    buffer_load_dwordx4 v[84:87], v3, s[64:67], s82 offen offset:2048 sc1
    s_waitcnt vmcnt(10) lgkmcnt(0)
    v_mfma_f32_32x32x16_bf16 v[16:31], v[232:235], v[88:91], v[16:31]
    ds_read_b64_tr_b16 v[224:225], v8 offset:32768
    ds_read_b64_tr_b16 v[226:227], v8 offset:33792
    v_mfma_f32_32x32x16_bf16 v[32:47], v[232:235], v[92:95], v[32:47]
    ds_read_b64_tr_b16 v[228:229], v9 offset:32768
    ds_read_b64_tr_b16 v[230:231], v9 offset:33792
    v_mfma_f32_32x32x16_bf16 v[48:63], v[236:239], v[88:91], v[48:63]
    v_mfma_f32_32x32x16_bf16 v[64:79], v[236:239], v[92:95], v[64:79]
    buffer_load_dwordx4 v[88:91], v2, s[64:67], s82 offen offset:3072 sc1
    buffer_load_dwordx4 v[92:95], v3, s[64:67], s82 offen offset:3072 sc1
    s_waitcnt vmcnt(10) lgkmcnt(0)
    v_mfma_f32_32x32x16_bf16 v[16:31], v[224:227], v[96:99], v[16:31]
    ds_read_b64_tr_b16 v[232:233], v10 offset:0
    ds_read_b64_tr_b16 v[234:235], v10 offset:1024
    v_mfma_f32_32x32x16_bf16 v[32:47], v[224:227], v[100:103], v[32:47]
    ds_read_b64_tr_b16 v[236:237], v11 offset:0
    ds_read_b64_tr_b16 v[238:239], v11 offset:1024
    v_mfma_f32_32x32x16_bf16 v[48:63], v[228:231], v[96:99], v[48:63]
    v_mfma_f32_32x32x16_bf16 v[64:79], v[228:231], v[100:103], v[64:79]
    s_add_u32 s82, s82, 4096
    buffer_load_dwordx4 v[96:99], v2, s[64:67], s82 offen offset:0 sc1
    buffer_load_dwordx4 v[100:103], v3, s[64:67], s82 offen offset:0 sc1
    s_waitcnt vmcnt(10) lgkmcnt(0)
    v_mfma_f32_32x32x16_bf16 v[16:31], v[232:235], v[104:107], v[16:31]
    ds_read_b64_tr_b16 v[224:225], v10 offset:8192
    ds_read_b64_tr_b16 v[226:227], v10 offset:9216
    v_mfma_f32_32x32x16_bf16 v[32:47], v[232:235], v[108:111], v[32:47]
    ds_read_b64_tr_b16 v[228:229], v11 offset:8192
    ds_read_b64_tr_b16 v[230:231], v11 offset:9216
    v_mfma_f32_32x32x16_bf16 v[48:63], v[236:239], v[104:107], v[48:63]
    v_mfma_f32_32x32x16_bf16 v[64:79], v[236:239], v[108:111], v[64:79]
    buffer_load_dwordx4 v[104:107], v2, s[64:67], s82 offen offset:1024 sc1
    buffer_load_dwordx4 v[108:111], v3, s[64:67], s82 offen offset:1024 sc1
    s_waitcnt vmcnt(10) lgkmcnt(0)
    v_mfma_f32_32x32x16_bf16 v[16:31], v[224:227], v[112:115], v[16:31]
    ds_read_b64_tr_b16 v[232:233], v10 offset:16384
    ds_read_b64_tr_b16 v[234:235], v10 offset:17408
    v_mfma_f32_32x32x16_bf16 v[32:47], v[224:227], v[116:119], v[32:47]
    ds_read_b64_tr_b16 v[236:237], v11 offset:16384
    ds_read_b64_tr_b16 v[238:239], v11 offset:17408
    v_mfma_f32_32x32x16_bf16 v[48:63], v[228:231], v[112:115], v[48:63]
    v_mfma_f32_32x32x16_bf16 v[64:79], v[228:231], v[116:119], v[64:79]
    s_waitcnt vmcnt(8) lgkmcnt(0)
    v_mfma_f32_32x32x16_bf16 v[16:31], v[232:235], v[120:123], v[16:31]
    ds_read_b64_tr_b16 v[224:225], v10 offset:24576
    ds_read_b64_tr_b16 v[226:227], v10 offset:25600
    v_mfma_f32_32x32x16_bf16 v[32:47], v[232:235], v[124:127], v[32:47]
    ds_read_b64_tr_b16 v[228:229], v11 offset:24576
    ds_read_b64_tr_b16 v[230:231], v11 offset:25600
    v_mfma_f32_32x32x16_bf16 v[48:63], v[236:239], v[120:123], v[48:63]
    v_mfma_f32_32x32x16_bf16 v[64:79], v[236:239], v[124:127], v[64:79]
    s_waitcnt vmcnt(6) lgkmcnt(0)
    v_mfma_f32_32x32x16_bf16 v[16:31], v[224:227], v[80:83], v[16:31]
    ds_read_b64_tr_b16 v[232:233], v10 offset:32768
    ds_read_b64_tr_b16 v[234:235], v10 offset:33792
    v_mfma_f32_32x32x16_bf16 v[32:47], v[224:227], v[84:87], v[32:47]
    ds_read_b64_tr_b16 v[236:237], v11 offset:32768
    ds_read_b64_tr_b16 v[238:239], v11 offset:33792
    v_mfma_f32_32x32x16_bf16 v[48:63], v[228:231], v[80:83], v[48:63]
    v_mfma_f32_32x32x16_bf16 v[64:79], v[228:231], v[84:87], v[64:79]
    s_waitcnt vmcnt(4) lgkmcnt(0)
    v_mfma_f32_32x32x16_bf16 v[16:31], v[232:235], v[88:91], v[16:31]
    ds_read_b64_tr_b16 v[224:225], v8 offset:0
    ds_read_b64_tr_b16 v[226:227], v8 offset:1024
    v_mfma_f32_32x32x16_bf16 v[32:47], v[232:235], v[92:95], v[32:47]
    ds_read_b64_tr_b16 v[228:229], v9 offset:0
    ds_read_b64_tr_b16 v[230:231], v9 offset:1024
    v_mfma_f32_32x32x16_bf16 v[48:63], v[236:239], v[88:91], v[48:63]
    v_mfma_f32_32x32x16_bf16 v[64:79], v[236:239], v[92:95], v[64:79]
    s_waitcnt vmcnt(2) lgkmcnt(0)
    v_mfma_f32_32x32x16_bf16 v[16:31], v[224:227], v[96:99], v[16:31]
    ds_read_b64_tr_b16 v[232:233], v8 offset:8192
    ds_read_b64_tr_b16 v[234:235], v8 offset:9216
    v_mfma_f32_32x32x16_bf16 v[32:47], v[224:227], v[100:103], v[32:47]
    ds_read_b64_tr_b16 v[236:237], v9 offset:8192
    ds_read_b64_tr_b16 v[238:239], v9 offset:9216
    v_mfma_f32_32x32x16_bf16 v[48:63], v[228:231], v[96:99], v[48:63]
    v_mfma_f32_32x32x16_bf16 v[64:79], v[228:231], v[100:103], v[64:79]
    s_waitcnt vmcnt(0) lgkmcnt(0)
    s_cmp_ge_u32 s3, 2
    s_cbranch_scc1 M_SKIP21
    v_mfma_f32_32x32x16_bf16 v[16:31], v[232:235], v[104:107], v[16:31]
    v_mfma_f32_32x32x16_bf16 v[32:47], v[232:235], v[108:111], v[32:47]
    v_mfma_f32_32x32x16_bf16 v[48:63], v[236:239], v[104:107], v[48:63]
    v_mfma_f32_32x32x16_bf16 v[64:79], v[236:239], v[108:111], v[64:79]
M_SKIP21:
    v_and_b32 v8, 31, v0
    v_mul_u32_u24 v10, 136, v8
    v_lshl_add_u32 v10, v6, 3, v10
    s_and_b32 s68, s3, 1
    s_mul_i32 s68, s68, 4352
    s_lshr_b32 s69, s3, 1
    s_lshl_b32 s70, s69, 6
    s_add_u32 s68, s68, s70
    s_add_u32 s68, s68, 60928
    v_add_u32 v10, s68, v10
    v_lshlrev_b32 v12, 10, v8
    v_lshl_add_u32 v12, v6, 4, v12
    s_lshl_b32 s68, s51, 16
    s_and_b32 s71, s3, 1
    s_lshl_b32 s71, s71, 15
    s_add_u32 s68, s68, s71
    s_lshl_b32 s71, s52, 7
    s_add_u32 s68, s68, s71
    s_add_u32 s76, s68, s70
    s_add_u32 s68, s3, 1
    s_and_b32 s68, s68, 3
    s_lshl_b32 s68, s68, 11
    s_add_u32 s68, s68, 73920
    v_add_u32 v13, s68, v2
    s_add_u32 s68, s3, 2
    s_and_b32 s68, s68, 3
    s_lshl_b32 s68, s68, 11
    s_add_u32 s68, s68, 73920
    v_add_u32 v14, s68, v2
    s_add_u32 s68, s3, 3
    s_and_b32 s68, s68, 3
    s_lshl_b32 s68, s68, 11
    s_add_u32 s68, s68, 73920
    v_add_u32 v15, s68, v2
    s_cmp_lg_u32 s3, 0
    s_cbranch_scc1 M_RW1
    ds_write_b128 v4, v[32:35] offset:0
    ds_write_b128 v4, v[36:39] offset:1024
    ds_write_b128 v4, v[40:43] offset:8192
    ds_write_b128 v4, v[44:47] offset:9216
    ds_write_b128 v4, v[48:51] offset:16384
    ds_write_b128 v4, v[52:55] offset:17408
    ds_write_b128 v4, v[56:59] offset:24576
    ds_write_b128 v4, v[60:63] offset:25600
    ds_write_b128 v4, v[64:67] offset:32768
    ds_write_b128 v4, v[68:71] offset:33792
    ds_write_b128 v4, v[72:75] offset:40960
    ds_write_b128 v4, v[76:79] offset:41984
    s_branch M_RWD
M_RW1:
    s_cmp_lg_u32 s3, 1
    s_cbranch_scc1 M_RW2
    ds_write_b128 v4, v[48:51] offset:0
    ds_write_b128 v4, v[52:55] offset:1024
    ds_write_b128 v4, v[56:59] offset:8192
    ds_write_b128 v4, v[60:63] offset:9216
    ds_write_b128 v4, v[64:67] offset:16384
    ds_write_b128 v4, v[68:71] offset:17408
    ds_write_b128 v4, v[72:75] offset:24576
    ds_write_b128 v4, v[76:79] offset:25600
    ds_write_b128 v4, v[16:19] offset:32768
    ds_write_b128 v4, v[20:23] offset:33792
    ds_write_b128 v4, v[24:27] offset:40960
    ds_write_b128 v4, v[28:31] offset:41984
    v_mov_b32 v16, v32
    v_mov_b32 v17, v33
    v_mov_b32 v18, v34
    v_mov_b32 v19, v35
    v_mov_b32 v20, v36
    v_mov_b32 v21, v37
    v_mov_b32 v22, v38
    v_mov_b32 v23, v39
    v_mov_b32 v24, v40
    v_mov_b32 v25, v41
    v_mov_b32 v26, v42
    v_mov_b32 v27, v43
    v_mov_b32 v28, v44
    v_mov_b32 v29, v45
    v_mov_b32 v30, v46
    v_mov_b32 v31, v47
    s_branch M_RWD
M_RW2:
    s_cmp_lg_u32 s3, 2
    s_cbranch_scc1 M_RW3
    ds_write_b128 v4, v[64:67] offset:0
    ds_write_b128 v4, v[68:71] offset:1024
    ds_write_b128 v4, v[72:75] offset:8192
    ds_write_b128 v4, v[76:79] offset:9216
    ds_write_b128 v4, v[16:19] offset:16384
    ds_write_b128 v4, v[20:23] offset:17408
    ds_write_b128 v4, v[24:27] offset:24576
    ds_write_b128 v4, v[28:31] offset:25600
    ds_write_b128 v4, v[32:35] offset:32768
    ds_write_b128 v4, v[36:39] offset:33792
    ds_write_b128 v4, v[40:43] offset:40960
    ds_write_b128 v4, v[44:47] offset:41984
    v_mov_b32 v16, v48
    v_mov_b32 v17, v49
    v_mov_b32 v18, v50
    v_mov_b32 v19, v51
    v_mov_b32 v20, v52
    v_mov_b32 v21, v53
    v_mov_b32 v22, v54
    v_mov_b32 v23, v55
    v_mov_b32 v24, v56
    v_mov_b32 v25, v57
    v_mov_b32 v26, v58
    v_mov_b32 v27, v59
    v_mov_b32 v28, v60
    v_mov_b32 v29, v61
    v_mov_b32 v30, v62
    v_mov_b32 v31, v63
    s_branch M_RWD
M_RW3:
    ds_write_b128 v4, v[16:19] offset:0
    ds_write_b128 v4, v[20:23] offset:1024
    ds_write_b128 v4, v[24:27] offset:8192
    ds_write_b128 v4, v[28:31] offset:9216
    ds_write_b128 v4, v[32:35] offset:16384
    ds_write_b128 v4, v[36:39] offset:17408
    ds_write_b128 v4, v[40:43] offset:24576
    ds_write_b128 v4, v[44:47] offset:25600
    ds_write_b128 v4, v[48:51] offset:32768
    ds_write_b128 v4, v[52:55] offset:33792
    ds_write_b128 v4, v[56:59] offset:40960
    ds_write_b128 v4, v[60:63] offset:41984
    v_mov_b32 v16, v64
    v_mov_b32 v17, v65
    v_mov_b32 v18, v66
    v_mov_b32 v19, v67
    v_mov_b32 v20, v68
    v_mov_b32 v21, v69
    v_mov_b32 v22, v70
    v_mov_b32 v23, v71
    v_mov_b32 v24, v72
    v_mov_b32 v25, v73
    v_mov_b32 v26, v74
    v_mov_b32 v27, v75
    v_mov_b32 v28, v76
    v_mov_b32 v29, v77
    v_mov_b32 v30, v78
    v_mov_b32 v31, v79
M_RWD:
    s_waitcnt lgkmcnt(0)
    s_barrier
    ds_read_b128 v[80:83], v13 offset:32768
    ds_read_b128 v[84:87], v13 offset:33792
    ds_read_b128 v[88:91], v13 offset:40960
    ds_read_b128 v[92:95], v13 offset:41984
    ds_read_b128 v[96:99], v14 offset:16384
    ds_read_b128 v[100:103], v14 offset:17408
    ds_read_b128 v[104:107], v14 offset:24576
    ds_read_b128 v[108:111], v14 offset:25600
    ds_read_b128 v[112:115], v15 offset:0
    ds_read_b128 v[116:119], v15 offset:1024
    ds_read_b128 v[120:123], v15 offset:8192
    ds_read_b128 v[124:127], v15 offset:9216
    ds_read_b64 v[32:33], v10 offset:0
    ds_read_b64 v[34:35], v10 offset:16
    ds_read_b64 v[36:37], v10 offset:32
    ds_read_b64 v[38:39], v10 offset:48
    s_mov_b32 s78, 0x00003f80
    s_mov_b32 s79, 0x3f800000
    s_waitcnt lgkmcnt(8)
    v_pk_add_f32 v[16:17], v[16:17], v[80:81]
    v_pk_add_f32 v[18:19], v[18:19], v[82:83]
    v_pk_add_f32 v[20:21], v[20:21], v[84:85]
    v_pk_add_f32 v[22:23], v[22:23], v[86:87]
    v_pk_add_f32 v[24:25], v[24:25], v[88:89]
    v_pk_add_f32 v[26:27], v[26:27], v[90:91]
    v_pk_add_f32 v[28:29], v[28:29], v[92:93]
    v_pk_add_f32 v[30:31], v[30:31], v[94:95]
    s_waitcnt lgkmcnt(4)
    v_pk_add_f32 v[96:97], v[96:97], v[112:113]
    v_pk_add_f32 v[98:99], v[98:99], v[114:115]
    v_pk_add_f32 v[100:101], v[100:101], v[116:117]
    v_pk_add_f32 v[102:103], v[102:103], v[118:119]
    v_pk_add_f32 v[104:105], v[104:105], v[120:121]
    v_pk_add_f32 v[106:107], v[106:107], v[122:123]
    v_pk_add_f32 v[108:109], v[108:109], v[124:125]
    v_pk_add_f32 v[110:111], v[110:111], v[126:127]
    v_pk_add_f32 v[16:17], v[16:17], v[96:97]
    v_pk_add_f32 v[18:19], v[18:19], v[98:99]
    v_pk_add_f32 v[20:21], v[20:21], v[100:101]
    v_pk_add_f32 v[22:23], v[22:23], v[102:103]
    v_pk_add_f32 v[24:25], v[24:25], v[104:105]
    v_pk_add_f32 v[26:27], v[26:27], v[106:107]
    v_pk_add_f32 v[28:29], v[28:29], v[108:109]
    v_pk_add_f32 v[30:31], v[30:31], v[110:111]
    v_cvt_pk_bf16_f32 v16, 0, v16
    v_cvt_pk_bf16_f32 v17, 0, v17
    v_cvt_pk_bf16_f32 v18, 0, v18
    v_cvt_pk_bf16_f32 v19, 0, v19
    v_cvt_pk_bf16_f32 v20, 0, v20
    v_cvt_pk_bf16_f32 v21, 0, v21
    v_cvt_pk_bf16_f32 v22, 0, v22
    v_cvt_pk_bf16_f32 v23, 0, v23
    v_cvt_pk_bf16_f32 v24, 0, v24
    v_cvt_pk_bf16_f32 v25, 0, v25
    v_cvt_pk_bf16_f32 v26, 0, v26
    v_cvt_pk_bf16_f32 v27, 0, v27
    v_cvt_pk_bf16_f32 v28, 0, v28
    v_cvt_pk_bf16_f32 v29, 0, v29
    v_cvt_pk_bf16_f32 v30, 0, v30
    v_cvt_pk_bf16_f32 v31, 0, v31
    s_waitcnt lgkmcnt(0)
    v_dot2_f32_bf16 v16, v32, s78, v16
    v_dot2_f32_bf16 v17, v32, s79, v17
    v_dot2_f32_bf16 v18, v33, s78, v18
    v_dot2_f32_bf16 v19, v33, s79, v19
    v_dot2_f32_bf16 v20, v34, s78, v20
    v_dot2_f32_bf16 v21, v34, s79, v21
    v_dot2_f32_bf16 v22, v35, s78, v22
    v_dot2_f32_bf16 v23, v35, s79, v23
    v_dot2_f32_bf16 v24, v36, s78, v24
    v_dot2_f32_bf16 v25, v36, s79, v25
    v_dot2_f32_bf16 v26, v37, s78, v26
    v_dot2_f32_bf16 v27, v37, s79, v27
    v_dot2_f32_bf16 v28, v38, s78, v28
    v_dot2_f32_bf16 v29, v38, s79, v29
    v_dot2_f32_bf16 v30, v39, s78, v30
    v_dot2_f32_bf16 v31, v39, s79, v31
    s_nop 0
    v_cvt_pk_bf16_f32 v40, v16, v17
    v_cvt_pk_bf16_f32 v41, v18, v19
    v_cvt_pk_bf16_f32 v42, v20, v21
    v_cvt_pk_bf16_f32 v43, v22, v23
    v_cvt_pk_bf16_f32 v44, v24, v25
    v_cvt_pk_bf16_f32 v45, v26, v27
    v_cvt_pk_bf16_f32 v46, v28, v29
    v_cvt_pk_bf16_f32 v47, v30, v31
    s_nop 1
    v_permlane32_swap_b32 v40, v42
    v_permlane32_swap_b32 v41, v43
    v_permlane32_swap_b32 v44, v46
    v_permlane32_swap_b32 v45, v47
    buffer_store_dwordx4 v[40:43], v12, s[60:63], s76 offen offset:0
    buffer_store_dwordx4 v[44:47], v12, s[60:63], s76 offen offset:32
K_END:
    s_endpgm
.section .rodata,"a"
.p2align 6
.amdhsa_kernel parallel_sum__ssm_conv_s4__swiglu_ffn__prompt_kernel
  .amdhsa_next_free_vgpr 256
  .amdhsa_next_free_sgpr 102
  .amdhsa_accum_offset 256
  .amdhsa_group_segment_fixed_size 0
  .amdhsa_kernarg_size 128
  .amdhsa_user_sgpr_count 2
  .amdhsa_user_sgpr_kernarg_segment_ptr 1
  .amdhsa_system_sgpr_workgroup_id_x 1
.end_amdhsa_kernel
```
